```python
import torch

def _softmax(x, axis=-1):
    return torch.softmax(x, dim=axis)
def _gelu(x):
    return torch.nn.functional.gelu(x, approximate="tanh")
def _silu(x):
    return torch.nn.functional.silu(x)
def _sigmoid(x):
    return torch.sigmoid(x)
def _layernorm(x, axis=-1, eps=1e-5):
    m = x.mean(dim=axis, keepdim=True)
    v = x.var(dim=axis, keepdim=True, unbiased=False)
    return (x - m) / torch.sqrt(v + eps)
def _scatter_add(tgt, idx, src, axis=0):
    return tgt.clone().index_add_(axis, idx, src)
def _segment_sum(src, seg, n):
    out = torch.zeros((n,) + src.shape[1:], dtype=src.dtype)
    return out.index_add_(0, seg, src)
def _pad(x, pw):
    flat = tuple(v for pair in reversed(pw) for v in pair)
    return torch.nn.functional.pad(x, flat)

kernel_name = 'standalone__gqa_softmax__sampling'

def setup_inputs():

    _w = (lambda a: (lambda t: t.to(torch.bfloat16) if t.is_floating_point() else t)(torch.as_tensor(a)))
    B, Hq, Hkv, Sq, Sk, D = 8, 32, 8, 32, 8192, 128
    return {
        "q": _w((lambda *s: torch.randn(*s, dtype=torch.bfloat16) * 0.8)(B, Hq, Sq, D)),
        "k": _w((lambda *s: torch.randn(*s, dtype=torch.bfloat16) * 0.8)(B, Hkv, Sk, D)),
        "v": _w((lambda *s: torch.randn(*s, dtype=torch.bfloat16) * 0.05)(B, Hkv, Sk, D)),
    }

def reference(q, k, v):
    B, Hq, Sq, D = q.shape
    Hkv = k.shape[1]
    rep = Hq // Hkv
    k = (lambda x, n, axis: torch.repeat_interleave(x, n, dim=axis))(k, rep, axis=1)
    v = (lambda x, n, axis: torch.repeat_interleave(x, n, dim=axis))(v, rep, axis=1)
    scale = D ** -0.5
    scores = torch.einsum("bhqd,bhkd->bhqk", q, k) * scale
    p = _softmax(scores, axis=-1)
    return torch.einsum("bhqk,bhkd->bhqd", p, v)
```

```asm
; @launch grid=(256,1,1) block=(320,1,1) lds=131392
.amdgcn_target "amdgcn-amd-amdhsa--gfx950"
.text
.globl standalone__gqa_softmax__sampling_kernel
.p2align 8
.type standalone__gqa_softmax__sampling_kernel,@function
standalone__gqa_softmax__sampling_kernel:
  s_cmp_ge_u32 s2, 256
  s_cbranch_scc1 L_end
  s_load_dwordx4 s[4:7], s[0:1], 0
  s_load_dwordx4 s[8:11], s[0:1], 16
  s_load_dwordx4 s[12:15], s[0:1], 32
  v_lshrrev_b32 v1, 6, v0
  v_and_b32 v0, 63, v0
  v_readfirstlane_b32 s3, v1
  s_and_b32 s50, s2, 7
  s_bfe_u32 s41, s2, 131075
  s_lshr_b32 s51, s2, 5
  s_lshl_b32 s40, s51, 3
  s_add_u32 s40, s40, s50
  s_cmp_lg_u32 s3, 0
  s_cbranch_scc1 L_cons
  s_getpc_b64 s[48:49]
L_pc:
  v_lshlrev_b32 v5, 7, v0
  v_mov_b32 v9, s49
  v_min_u32 v6, L_end - L_pc, v5
  v_add_co_u32 v6, vcc, s48, v6
  s_nop 1
  v_addc_co_u32 v7, vcc, 0, v9, vcc
  global_load_dword v8, v[6:7], off
  v_add_u32 v5, 8192, v5
  v_min_u32 v6, L_end - L_pc, v5
  v_add_co_u32 v6, vcc, s48, v6
  s_nop 1
  v_addc_co_u32 v7, vcc, 0, v9, vcc
  global_load_dword v8, v[6:7], off
  v_add_u32 v5, 8192, v5
  v_min_u32 v6, L_end - L_pc, v5
  v_add_co_u32 v6, vcc, s48, v6
  s_nop 1
  v_addc_co_u32 v7, vcc, 0, v9, vcc
  global_load_dword v8, v[6:7], off
  s_setprio 3
  s_lshl_b32 s50, s40, 21
  s_lshl_b32 s51, s41, 10
  s_add_u32 s50, s50, s51
  v_lshrrev_b32 v3, 4, v0
  v_and_b32 v4, 15, v0
  v_xor_b32 v5, v3, v4
  v_lshlrev_b32 v5, 4, v5
  v_lshl_add_u32 v10, v3, 8, v5
  v_xor_b32 v11, 64, v10
  v_xor_b32 v12, 0x80, v10
  v_xor_b32 v13, 0xc0, v10
  v_lshlrev_b32 v5, 1, v3
  v_xor_b32 v5, v5, v4
  v_lshlrev_b32 v5, 4, v5
  v_lshl_add_u32 v14, v3, 8, v5
  v_xor_b32 v15, 0x80, v14
  v_mov_b32 v25, v11
  v_mov_b32 v26, v12
  v_mov_b32 v27, v13
  s_lshl_b32 s53, s40, 15
  s_mov_b32 s26, 32768
  s_mov_b32 s27, 0x20000
  v_add_u32 v11, 3072, v11
  v_add_u32 v12, 6144, v12
  v_add_u32 v13, 9216, v13
  v_add_u32 v16, 6144, v14
  v_add_u32 v17, 9216, v15
  v_add_u32 v15, 3072, v15
  s_sub_u32 s18, 0x200000, s51
  s_mov_b32 s19, 0x20000
  s_mov_b32 s22, s18
  s_mov_b32 s23, 0x20000
  s_mov_b32 s54, 0
  s_mov_b32 s55, 0
  s_waitcnt lgkmcnt(0)
  s_add_u32 s16, s6, s50
  s_addc_u32 s17, s7, 0
  s_add_u32 s20, s8, s50
  s_addc_u32 s21, s9, 0
  s_mov_b32 m0, 131136
  s_mov_b64 exec, 1
  buffer_load_dword v10, s[16:19], 0 offen lds
  buffer_load_dword v10, s[20:23], 0 offen lds
  v_mov_b32 v30, s53
  global_load_lds_dword v30, s[10:11]
  s_mov_b64 exec, -1
  s_add_u32 s24, s4, s53
  s_addc_u32 s25, s5, 0
  s_mov_b32 m0, 98304
  s_movk_i32 s52, 0
  buffer_load_dwordx4 v10, s[24:27], s52 offen offset:0  lds
  buffer_load_dwordx4 v25, s[24:27], s52 offen offset:1024  lds
  buffer_load_dwordx4 v26, s[24:27], s52 offen offset:2048  lds
  buffer_load_dwordx4 v27, s[24:27], s52 offen offset:3072  lds
  s_mov_b32 m0, 102400
  s_movk_i32 s52, 4096
  buffer_load_dwordx4 v10, s[24:27], s52 offen offset:0  lds
  buffer_load_dwordx4 v25, s[24:27], s52 offen offset:1024  lds
  buffer_load_dwordx4 v26, s[24:27], s52 offen offset:2048  lds
  buffer_load_dwordx4 v27, s[24:27], s52 offen offset:3072  lds
  s_mov_b32 m0, 106496
  s_movk_i32 s52, 8192
  buffer_load_dwordx4 v10, s[24:27], s52 offen offset:0  lds
  buffer_load_dwordx4 v25, s[24:27], s52 offen offset:1024  lds
  buffer_load_dwordx4 v26, s[24:27], s52 offen offset:2048  lds
  buffer_load_dwordx4 v27, s[24:27], s52 offen offset:3072  lds
  s_mov_b32 m0, 110592
  s_movk_i32 s52, 12288
  buffer_load_dwordx4 v10, s[24:27], s52 offen offset:0  lds
  buffer_load_dwordx4 v25, s[24:27], s52 offen offset:1024  lds
  buffer_load_dwordx4 v26, s[24:27], s52 offen offset:2048  lds
  buffer_load_dwordx4 v27, s[24:27], s52 offen offset:3072  lds
  s_mov_b32 m0, 114688
  s_movk_i32 s52, 16384
  buffer_load_dwordx4 v10, s[24:27], s52 offen offset:0  lds
  buffer_load_dwordx4 v25, s[24:27], s52 offen offset:1024  lds
  buffer_load_dwordx4 v26, s[24:27], s52 offen offset:2048  lds
  buffer_load_dwordx4 v27, s[24:27], s52 offen offset:3072  lds
  s_mov_b32 m0, 118784
  s_movk_i32 s52, 20480
  buffer_load_dwordx4 v10, s[24:27], s52 offen offset:0  lds
  buffer_load_dwordx4 v25, s[24:27], s52 offen offset:1024  lds
  buffer_load_dwordx4 v26, s[24:27], s52 offen offset:2048  lds
  buffer_load_dwordx4 v27, s[24:27], s52 offen offset:3072  lds
  s_mov_b32 m0, 122880
  s_movk_i32 s52, 24576
  buffer_load_dwordx4 v10, s[24:27], s52 offen offset:0  lds
  buffer_load_dwordx4 v25, s[24:27], s52 offen offset:1024  lds
  buffer_load_dwordx4 v26, s[24:27], s52 offen offset:2048  lds
  buffer_load_dwordx4 v27, s[24:27], s52 offen offset:3072  lds
  s_mov_b32 m0, 126976
  s_movk_i32 s52, 28672
  buffer_load_dwordx4 v10, s[24:27], s52 offen offset:0  lds
  buffer_load_dwordx4 v25, s[24:27], s52 offen offset:1024  lds
  buffer_load_dwordx4 v26, s[24:27], s52 offen offset:2048  lds
  buffer_load_dwordx4 v27, s[24:27], s52 offen offset:3072  lds
  s_bfe_u32 m0, s54, 1048578
  s_nop 0
  buffer_load_dwordx4 v10, s[16:19], s54 offen offset:0 nt lds
  buffer_load_dwordx4 v11, s[16:19], s54 offen offset:1024 nt lds
  buffer_load_dwordx4 v12, s[16:19], s54 offen offset:2048 nt lds
  buffer_load_dwordx4 v13, s[16:19], s54 offen offset:3072 nt lds
  s_add_u32 s54, s54, 16384
  s_bfe_u32 m0, s54, 1048578
  s_nop 0
  buffer_load_dwordx4 v10, s[16:19], s54 offen offset:0 nt lds
  buffer_load_dwordx4 v11, s[16:19], s54 offen offset:1024 nt lds
  buffer_load_dwordx4 v12, s[16:19], s54 offen offset:2048 nt lds
  buffer_load_dwordx4 v13, s[16:19], s54 offen offset:3072 nt lds
  s_add_u32 s54, s54, 16384
  s_bfe_u32 m0, s54, 1048578
  s_nop 0
  buffer_load_dwordx4 v10, s[16:19], s54 offen offset:0 nt lds
  buffer_load_dwordx4 v11, s[16:19], s54 offen offset:1024 nt lds
  buffer_load_dwordx4 v12, s[16:19], s54 offen offset:2048 nt lds
  buffer_load_dwordx4 v13, s[16:19], s54 offen offset:3072 nt lds
  s_add_u32 s54, s54, 16384
  s_bfe_u32 m0, s54, 1048578
  s_nop 0
  buffer_load_dwordx4 v10, s[16:19], s54 offen offset:0 nt lds
  buffer_load_dwordx4 v11, s[16:19], s54 offen offset:1024 nt lds
  buffer_load_dwordx4 v12, s[16:19], s54 offen offset:2048 nt lds
  buffer_load_dwordx4 v13, s[16:19], s54 offen offset:3072 nt lds
  s_add_u32 s54, s54, 16384
  s_mov_b32 s36, s12
  s_mov_b32 s37, s13
  s_mov_b32 s38, 256
  s_mov_b32 s39, 0x20000
  s_lshl_b32 s64, s40, 2
  v_mov_b32 v20, 131072
  s_and_b32 s52, s40, 7
  s_lshl_b32 s52, s52, 20
  s_lshr_b32 s51, s40, 3
  s_lshl_b32 s51, s51, 17
  s_add_u32 s52, s52, s51
  s_add_u32 s32, s14, s52
  s_addc_u32 s33, s15, 0
  s_mov_b32 s34, 131072
  s_mov_b32 s35, 0x20000
  v_and_b32 v24, 31, v0
  v_lshlrev_b32 v24, 7, v24
  s_mul_i32 s60, s41, 17408
  s_lshl_b32 s52, s40, 15
  s_add_u32 s28, s10, s52
  s_addc_u32 s29, s11, 0
  s_mov_b32 s30, 32768
  s_mov_b32 s31, 0x20000
  v_lshlrev_b32 v19, 8, v4
  v_and_b32 v5, 1, v3
  v_lshl_add_u32 v19, v5, 13, v19
  s_and_b32 s52, s41, 1
  s_lshl_b32 s78, s52, 12
  s_and_b32 s52, s41, 2
  s_lshl_b32 s52, s52, 6
  s_add_u32 s78, s78, s52
  s_mul_i32 s52, s41, 4
  s_add_u32 s56, s52, 12
  s_add_u32 s62, s52, 28
  s_mov_b32 s57, 0
  s_mov_b32 s58, 1193319
  s_mov_b32 s59, 0
  s_mov_b32 s61, 0
  s_add_u32 s68, s14, 114688
  s_addc_u32 s69, s15, 0
  s_mov_b32 s70, 8390656
  s_mov_b32 s71, 0x20000
  s_and_b32 s52, s2, 7
  s_mul_i32 s51, s52, 1048832
  v_and_b32 v28, 31, v0
  v_lshl_add_u32 v29, v28, 2, s51
  v_lshrrev_b32 v5, 2, v28
  v_lshlrev_b32 v5, 5, v5
  v_and_b32 v28, 3, v28
  v_add_u32 v28, v28, v5
  s_lshl_b32 s52, s52, 2
  v_add_u32 v28, s52, v28
  s_lshr_b32 s65, s2, 3
  s_lshl_b32 s65, s65, 2
  s_add_u32 s65, s65, s51
  v_mov_b32 v30, 0
  v_mov_b32 v23, 0
  s_movk_i32 s72, -1000
  s_movk_i32 s73, 1000
  s_bfe_u32 m0, s54, 1048578
  s_nop 0
  buffer_load_dwordx4 v10, s[16:19], s54 offen offset:0 nt lds
  buffer_load_dwordx4 v11, s[16:19], s54 offen offset:1024 nt lds
  buffer_load_dwordx4 v12, s[16:19], s54 offen offset:2048 nt lds
  buffer_load_dwordx4 v13, s[16:19], s54 offen offset:3072 nt lds
  s_add_u32 s54, s54, 16384
  s_bfe_u32 m0, s54, 1048578
  s_nop 0
  buffer_load_dwordx4 v10, s[16:19], s54 offen offset:0 nt lds
  buffer_load_dwordx4 v11, s[16:19], s54 offen offset:1024 nt lds
  s_waitcnt vmcnt(22)
  s_barrier
  s_waitcnt vmcnt(21)
  buffer_load_dwordx4 v12, s[16:19], s54 offen offset:2048 nt lds
  s_waitcnt vmcnt(21)
  buffer_load_dwordx4 v13, s[16:19], s54 offen offset:3072 nt lds
  s_add_u32 s54, s54, 16384
  s_bfe_u32 s52, s55, 1048578
  s_or_b32 m0, s52, 65536
  s_waitcnt vmcnt(21)
  buffer_load_dwordx4 v14, s[20:23], s55 offen offset:0 nt lds
  s_waitcnt vmcnt(21)
  buffer_load_dwordx4 v15, s[20:23], s55 offen offset:1024 nt lds
  s_waitcnt vmcnt(21)
  buffer_load_dwordx4 v16, s[20:23], s55 offen offset:2048 nt lds
  s_waitcnt vmcnt(21)
  buffer_load_dwordx4 v17, s[20:23], s55 offen offset:3072 nt lds
  s_add_u32 s55, s55, 16384
  s_bfe_u32 s52, s55, 1048578
  s_or_b32 m0, s52, 65536
  s_waitcnt vmcnt(21)
  buffer_load_dwordx4 v14, s[20:23], s55 offen offset:0 nt lds
  s_waitcnt vmcnt(21)
  buffer_load_dwordx4 v15, s[20:23], s55 offen offset:1024 nt lds
  s_waitcnt vmcnt(21)
  buffer_load_dwordx4 v16, s[20:23], s55 offen offset:2048 nt lds
  s_waitcnt vmcnt(21)
  buffer_load_dwordx4 v17, s[20:23], s55 offen offset:3072 nt lds
  s_add_u32 s55, s55, 16384
  s_bfe_u32 m0, s54, 1048578
  s_waitcnt vmcnt(21)
  buffer_load_dwordx4 v10, s[16:19], s54 offen offset:0 nt lds
  s_waitcnt vmcnt(21)
  buffer_load_dwordx4 v11, s[16:19], s54 offen offset:1024 nt lds
  s_waitcnt vmcnt(21)
  buffer_load_dwordx4 v12, s[16:19], s54 offen offset:2048 nt lds
  s_waitcnt vmcnt(21)
  buffer_load_dwordx4 v13, s[16:19], s54 offen offset:3072 nt lds
  s_add_u32 s54, s54, 16384
  s_bfe_u32 m0, s54, 1048578
  s_waitcnt vmcnt(21)
  buffer_load_dwordx4 v10, s[16:19], s54 offen offset:0 nt lds
  s_waitcnt vmcnt(21)
  s_barrier
  buffer_load_dwordx4 v11, s[16:19], s54 offen offset:1024 nt lds
  s_waitcnt vmcnt(21)
  buffer_load_dwordx4 v12, s[16:19], s54 offen offset:2048 nt lds
  s_waitcnt vmcnt(21)
  buffer_load_dwordx4 v13, s[16:19], s54 offen offset:3072 nt lds
  s_add_u32 s54, s54, 16384
  s_bfe_u32 s52, s55, 1048578
  s_or_b32 m0, s52, 65536
  s_waitcnt vmcnt(21)
  buffer_load_dwordx4 v14, s[20:23], s55 offen offset:0 nt lds
  s_waitcnt vmcnt(21)
  buffer_load_dwordx4 v15, s[20:23], s55 offen offset:1024 nt lds
  s_waitcnt vmcnt(21)
  buffer_load_dwordx4 v16, s[20:23], s55 offen offset:2048 nt lds
  s_waitcnt vmcnt(21)
  buffer_load_dwordx4 v17, s[20:23], s55 offen offset:3072 nt lds
  s_add_u32 s55, s55, 16384
  s_bfe_u32 s52, s55, 1048578
  s_or_b32 m0, s52, 65536
  s_waitcnt vmcnt(21)
  buffer_load_dwordx4 v14, s[20:23], s55 offen offset:0 nt lds
  s_waitcnt vmcnt(21)
  buffer_load_dwordx4 v15, s[20:23], s55 offen offset:1024 nt lds
  s_waitcnt vmcnt(21)
  buffer_load_dwordx4 v16, s[20:23], s55 offen offset:2048 nt lds
  s_waitcnt vmcnt(21)
  buffer_load_dwordx4 v17, s[20:23], s55 offen offset:3072 nt lds
  s_add_u32 s55, s55, 16384
L_ldloop:
  v_cmp_le_u32 vcc, s61, v30
  s_add_u32 s61, s61, 1
  v_mov_b32 v31, s61
  s_bcnt1_i32_b32 s63, vcc_lo
  buffer_load_dword v30, v29, s[68:71], 0 offen nt
  s_mov_b64 exec, 1
  buffer_store_dword v31, off, s[68:71], s65
  s_mov_b64 exec, -1
  s_cmp_eq_u32 s61, 3
  s_cbranch_scc1 L_hs0
  s_cmp_eq_u32 s61, 5
  s_cbranch_scc1 L_hs1
L_go:
  s_cmp_lt_i32 s63, s72
  s_cbranch_scc1 L_lv0
  s_cmp_ge_i32 s63, s73
  s_cbranch_scc1 L_lv2
  s_bfe_u32 m0, s54, 1048578
  s_waitcnt vmcnt(23)
  buffer_load_dwordx4 v10, s[16:19], s54 offen offset:0 nt lds
  s_sub_u32 s56, s56, 1
  s_cbranch_scc1 L_bar0
L_barret0:
  s_waitcnt vmcnt(23)
  buffer_load_dwordx4 v11, s[16:19], s54 offen offset:1024 nt lds
  s_sub_u32 s56, s56, 1
  s_cbranch_scc1 L_bar1
L_barret1:
  s_waitcnt vmcnt(23)
  buffer_load_dwordx4 v12, s[16:19], s54 offen offset:2048 nt lds
  s_sub_u32 s56, s56, 1
  s_cbranch_scc1 L_bar2
L_barret2:
  s_waitcnt vmcnt(23)
  buffer_load_dwordx4 v13, s[16:19], s54 offen offset:3072 nt lds
  s_sub_u32 s56, s56, 1
  s_cbranch_scc1 L_bar3
L_barret3:
  s_add_u32 s54, s54, 16384
  s_bfe_u32 m0, s54, 1048578
  s_waitcnt vmcnt(23)
  buffer_load_dwordx4 v10, s[16:19], s54 offen offset:0 nt lds
  s_sub_u32 s56, s56, 1
  s_cbranch_scc1 L_bar4
L_barret4:
  s_waitcnt vmcnt(23)
  buffer_load_dwordx4 v11, s[16:19], s54 offen offset:1024 nt lds
  s_sub_u32 s56, s56, 1
  s_cbranch_scc1 L_bar5
L_barret5:
  s_waitcnt vmcnt(23)
  buffer_load_dwordx4 v12, s[16:19], s54 offen offset:2048 nt lds
  s_sub_u32 s56, s56, 1
  s_cbranch_scc1 L_bar6
L_barret6:
  s_waitcnt vmcnt(23)
  buffer_load_dwordx4 v13, s[16:19], s54 offen offset:3072 nt lds
  s_sub_u32 s56, s56, 1
  s_cbranch_scc1 L_bar7
L_barret7:
  s_add_u32 s54, s54, 16384
  s_bfe_u32 s52, s55, 1048578
  s_or_b32 m0, s52, 65536
  s_waitcnt vmcnt(23)
  buffer_load_dwordx4 v14, s[20:23], s55 offen offset:0 nt lds
  s_sub_u32 s56, s56, 1
  s_cbranch_scc1 L_bar8
L_barret8:
  s_waitcnt vmcnt(23)
  buffer_load_dwordx4 v15, s[20:23], s55 offen offset:1024 nt lds
  s_sub_u32 s56, s56, 1
  s_cbranch_scc1 L_bar9
L_barret9:
  s_waitcnt vmcnt(23)
  buffer_load_dwordx4 v16, s[20:23], s55 offen offset:2048 nt lds
  s_sub_u32 s56, s56, 1
  s_cbranch_scc1 L_bar10
L_barret10:
  s_waitcnt vmcnt(23)
  buffer_load_dwordx4 v17, s[20:23], s55 offen offset:3072 nt lds
  s_sub_u32 s56, s56, 1
  s_cbranch_scc1 L_bar11
L_barret11:
  s_add_u32 s55, s55, 16384
  s_bfe_u32 s52, s55, 1048578
  s_or_b32 m0, s52, 65536
  s_waitcnt vmcnt(23)
  buffer_load_dwordx4 v14, s[20:23], s55 offen offset:0 nt lds
  s_sub_u32 s56, s56, 1
  s_cbranch_scc1 L_bar12
L_barret12:
  s_waitcnt vmcnt(23)
  buffer_load_dwordx4 v15, s[20:23], s55 offen offset:1024 nt lds
  s_sub_u32 s56, s56, 1
  s_cbranch_scc1 L_bar13
L_barret13:
  s_waitcnt vmcnt(23)
  buffer_load_dwordx4 v16, s[20:23], s55 offen offset:2048 nt lds
  s_sub_u32 s56, s56, 1
  s_cbranch_scc1 L_bar14
L_barret14:
  s_waitcnt vmcnt(23)
  buffer_load_dwordx4 v17, s[20:23], s55 offen offset:3072 nt lds
  s_sub_u32 s56, s56, 1
  s_cbranch_scc1 L_bar15
L_barret15:
  s_add_u32 s55, s55, 16384
  s_bfe_u32 m0, s54, 1048578
  s_waitcnt vmcnt(23)
  buffer_load_dwordx4 v10, s[16:19], s54 offen offset:0 nt lds
  s_sub_u32 s56, s56, 1
  s_cbranch_scc1 L_bar16
L_barret16:
  s_waitcnt vmcnt(23)
  buffer_load_dwordx4 v11, s[16:19], s54 offen offset:1024 nt lds
  s_sub_u32 s56, s56, 1
  s_cbranch_scc1 L_bar17
L_barret17:
  s_waitcnt vmcnt(23)
  buffer_load_dwordx4 v12, s[16:19], s54 offen offset:2048 nt lds
  s_sub_u32 s56, s56, 1
  s_cbranch_scc1 L_bar18
L_barret18:
  s_waitcnt vmcnt(23)
  buffer_load_dwordx4 v13, s[16:19], s54 offen offset:3072 nt lds
  s_sub_u32 s56, s56, 1
  s_cbranch_scc1 L_bar19
L_barret19:
  s_add_u32 s54, s54, 16384
  s_bfe_u32 m0, s54, 1048578
  s_waitcnt vmcnt(23)
  buffer_load_dwordx4 v10, s[16:19], s54 offen offset:0 nt lds
  s_sub_u32 s56, s56, 1
  s_cbranch_scc1 L_bar20
L_barret20:
  s_waitcnt vmcnt(21)
  buffer_load_dwordx4 v11, s[16:19], s54 offen offset:1024 nt lds
  s_sub_u32 s56, s56, 1
  s_cbranch_scc1 L_bar21
L_barret21:
  s_waitcnt vmcnt(21)
  buffer_load_dwordx4 v12, s[16:19], s54 offen offset:2048 nt lds
  s_sub_u32 s56, s56, 1
  s_cbranch_scc1 L_bar22
L_barret22:
  s_waitcnt vmcnt(21)
  buffer_load_dwordx4 v13, s[16:19], s54 offen offset:3072 nt lds
  s_sub_u32 s56, s56, 1
  s_cbranch_scc1 L_bar23
L_barret23:
  s_add_u32 s54, s54, 16384
  s_bfe_u32 s52, s55, 1048578
  s_or_b32 m0, s52, 65536
  s_waitcnt vmcnt(21)
  buffer_load_dwordx4 v14, s[20:23], s55 offen offset:0 nt lds
  s_sub_u32 s56, s56, 1
  s_cbranch_scc1 L_bar24
L_barret24:
  s_waitcnt vmcnt(21)
  buffer_load_dwordx4 v15, s[20:23], s55 offen offset:1024 nt lds
  s_sub_u32 s56, s56, 1
  s_cbranch_scc1 L_bar25
L_barret25:
  s_waitcnt vmcnt(21)
  buffer_load_dwordx4 v16, s[20:23], s55 offen offset:2048 nt lds
  s_sub_u32 s56, s56, 1
  s_cbranch_scc1 L_bar26
L_barret26:
  s_waitcnt vmcnt(21)
  buffer_load_dwordx4 v17, s[20:23], s55 offen offset:3072 nt lds
  s_sub_u32 s56, s56, 1
  s_cbranch_scc1 L_bar27
L_barret27:
  s_add_u32 s55, s55, 16384
  s_bfe_u32 s52, s55, 1048578
  s_or_b32 m0, s52, 65536
  s_waitcnt vmcnt(21)
  buffer_load_dwordx4 v14, s[20:23], s55 offen offset:0 nt lds
  s_sub_u32 s56, s56, 1
  s_cbranch_scc1 L_bar28
L_barret28:
  s_waitcnt vmcnt(21)
  buffer_load_dwordx4 v15, s[20:23], s55 offen offset:1024 nt lds
  s_sub_u32 s56, s56, 1
  s_cbranch_scc1 L_bar29
L_barret29:
  s_waitcnt vmcnt(21)
  buffer_load_dwordx4 v16, s[20:23], s55 offen offset:2048 nt lds
  s_sub_u32 s56, s56, 1
  s_cbranch_scc1 L_bar30
L_barret30:
  s_waitcnt vmcnt(21)
  buffer_load_dwordx4 v17, s[20:23], s55 offen offset:3072 nt lds
  s_sub_u32 s56, s56, 1
  s_cbranch_scc1 L_bar31
L_barret31:
  s_add_u32 s55, s55, 16384
  s_cmp_lg_u32 s61, 30
  s_cbranch_scc1 L_ldloop
L_ldtail:
  s_bfe_u32 s52, s55, 1048578
  s_or_b32 m0, s52, 65536
  s_waitcnt vmcnt(21)
  buffer_load_dwordx4 v14, s[20:23], s55 offen offset:0 nt lds
  s_waitcnt vmcnt(21)
  buffer_load_dwordx4 v15, s[20:23], s55 offen offset:1024 nt lds
  s_waitcnt vmcnt(21)
  buffer_load_dwordx4 v16, s[20:23], s55 offen offset:2048 nt lds
  s_waitcnt vmcnt(21)
  buffer_load_dwordx4 v17, s[20:23], s55 offen offset:3072 nt lds
  s_add_u32 s55, s55, 16384
  s_bfe_u32 s52, s55, 1048578
  s_or_b32 m0, s52, 65536
  s_waitcnt vmcnt(21)
  buffer_load_dwordx4 v14, s[20:23], s55 offen offset:0 nt lds
  s_waitcnt vmcnt(21)
  s_barrier
  buffer_load_dwordx4 v15, s[20:23], s55 offen offset:1024 nt lds
  s_waitcnt vmcnt(21)
  buffer_load_dwordx4 v16, s[20:23], s55 offen offset:2048 nt lds
  s_waitcnt vmcnt(21)
  buffer_load_dwordx4 v17, s[20:23], s55 offen offset:3072 nt lds
  s_add_u32 s55, s55, 16384
  s_bfe_u32 s52, s55, 1048578
  s_or_b32 m0, s52, 65536
  s_waitcnt vmcnt(21)
  buffer_load_dwordx4 v14, s[20:23], s55 offen offset:0 nt lds
  s_waitcnt vmcnt(21)
  buffer_load_dwordx4 v15, s[20:23], s55 offen offset:1024 nt lds
  s_waitcnt vmcnt(21)
  buffer_load_dwordx4 v16, s[20:23], s55 offen offset:2048 nt lds
  s_waitcnt vmcnt(21)
  buffer_load_dwordx4 v17, s[20:23], s55 offen offset:3072 nt lds
  s_add_u32 s55, s55, 16384
  s_bfe_u32 s52, s55, 1048578
  s_or_b32 m0, s52, 65536
  s_waitcnt vmcnt(21)
  buffer_load_dwordx4 v14, s[20:23], s55 offen offset:0 nt lds
  s_waitcnt vmcnt(21)
  buffer_load_dwordx4 v15, s[20:23], s55 offen offset:1024 nt lds
  s_waitcnt vmcnt(21)
  buffer_load_dwordx4 v16, s[20:23], s55 offen offset:2048 nt lds
  s_waitcnt vmcnt(21)
  buffer_load_dwordx4 v17, s[20:23], s55 offen offset:3072 nt lds
  s_add_u32 s55, s55, 16384
  s_mov_b32 m0, 131136
  s_waitcnt vmcnt(16)
  s_barrier
  s_waitcnt vmcnt(14)
  buffer_load_dword v19, s[28:31], s78 offen  lds
  s_add_u32 s78, s78, 16384
  s_waitcnt vmcnt(14)
  buffer_load_dword v19, s[28:31], s78 offen  lds
  s_add_u32 s78, s78, 16384
  s_waitcnt vmcnt(14)
  buffer_load_dword v24, s[32:35], s60 offen  lds
  s_add_u32 s60, s60, 4096
  s_waitcnt vmcnt(14)
  buffer_load_dword v24, s[32:35], s60 offen  lds
  s_add_u32 s60, s60, 4096
  s_waitcnt vmcnt(14)
  buffer_load_dword v24, s[32:35], s60 offen  lds
  s_add_u32 s60, s60, 4096
  s_waitcnt vmcnt(14)
  buffer_load_dword v24, s[32:35], s60 offen  lds
  s_add_u32 s60, s60, 4096
  s_waitcnt vmcnt(14)
  s_barrier
  s_waitcnt vmcnt(14)
  buffer_load_dword v24, s[32:35], s60 offen  lds
  s_add_u32 s60, s60, 4096
  s_waitcnt vmcnt(7)
  s_barrier
  s_endpgm
L_hs0:
  v_mov_b32 v22, 0
  buffer_load_dword v22, off, s[36:39], s64 sc1
  buffer_load_ubyte v23, v28, s[36:39], 0 offen sc1
  s_branch L_go
L_hs1:
  s_getreg_b32 s52, hwreg(HW_REG_XCC_ID, 0, 3)
  s_or_b32 s51, s52, 0x80
  v_cmp_ne_u32 vcc, s51, v23
  s_cbranch_vccnz L_nork
  s_lshl_b32 s52, s52, 2
  s_lshr_b32 s52, 1521362744, s52
  s_and_b32 s52, s52, 15
  s_sub_i32 s72, 22, s52
  s_sub_i32 s73, 34, s52
L_nork:
  v_and_b32 v21, 0x80808080, v22
  v_cmp_ne_u32 vcc, 0x80808080, v21
  s_cbranch_vccz L_hs2
  s_mov_b64 exec, 1
  s_add_u32 s52, s64, s41
L_hs1a:
  buffer_load_ubyte v21, off, s[36:39], s52 sc1
  s_waitcnt vmcnt(0)
  v_cmp_eq_u32 vcc, 0, v21
  s_cbranch_vccnz L_hs1a
  s_getreg_b32 s52, hwreg(HW_REG_XCC_ID, 0, 3)
  s_or_b32 s52, s52, 0x80
  v_mov_b32 v21, s52
  s_add_u32 s52, s64, s41
  buffer_store_byte v21, off, s[36:39], s52 sc1
L_hs1b:
  buffer_load_dword v22, off, s[36:39], s64 sc1
  s_waitcnt vmcnt(0)
  v_and_b32 v21, 0x80808080, v22
  v_cmp_ne_u32 vcc, 0x80808080, v21
  s_cbranch_vccz L_hs2
  v_mov_b32 v22, 0
  buffer_atomic_or v22, off, s[36:39], s64 sc0 sc1
  s_waitcnt vmcnt(0)
  v_and_b32 v21, 0x80808080, v22
  v_cmp_ne_u32 vcc, 0x80808080, v21
  s_cbranch_vccz L_hs2
  s_branch L_hs1b
L_hs2:
  s_mov_b64 exec, 1
  v_alignbit_b32 v21, v22, v22, 8
  v_xor_b32 v21, v21, v22
  v_and_b32 v21, 0x07070707, v21
  v_cmp_ne_u32 vcc, 0, v21
  v_mov_b32 v21, 4
  s_cbranch_vccnz L_hsfar
L_hs3:
  ds_write_b32 v20, v21
  s_mov_b64 exec, -1
  s_waitcnt lgkmcnt(0)
  v_and_b32 v21, 3, v0
  v_lshlrev_b32 v21, 7, v21
  s_mov_b32 s52, 69632
  buffer_load_dword v23, v21, s[32:35], s52 offen
  s_branch L_go
L_hsfar:
  s_mov_b64 exec, 15
  v_lshlrev_b32 v21, 7, v0
  v_mov_b32 v22, 0
  s_lshl_b32 s52, s41, 2
  s_add_u32 s52, s52, 69632
  buffer_store_dword v22, v21, s[32:35], s52 offen sc1
  s_mov_b64 exec, 1
  s_waitcnt vmcnt(0)
  s_getreg_b32 s52, hwreg(HW_REG_XCC_ID, 0, 3)
  s_or_b32 s52, s52, 0xc0
  v_mov_b32 v21, s52
  s_add_u32 s52, s64, s41
  buffer_store_byte v21, off, s[36:39], s52 sc1
L_hsfar2:
  v_mov_b32 v22, 0
  buffer_atomic_or v22, off, s[36:39], s64 sc0 sc1
  s_waitcnt vmcnt(0)
  v_and_b32 v21, 0x40404040, v22
  v_cmp_ne_u32 vcc, 0x40404040, v21
  s_cbranch_vccz L_hsfar3
  s_branch L_hsfar2
L_hsfar3:
  v_mov_b32 v21, 0
  s_branch L_hs3
L_lv0:
  s_bfe_u32 m0, s54, 1048578
  s_waitcnt vmcnt(22)
  buffer_load_dwordx4 v10, s[16:19], s54 offen offset:0 nt lds
  s_sub_u32 s56, s56, 1
  s_cbranch_scc1 L_bar32
L_barret32:
  s_waitcnt vmcnt(22)
  buffer_load_dwordx4 v11, s[16:19], s54 offen offset:1024 nt lds
  s_sub_u32 s56, s56, 1
  s_cbranch_scc1 L_bar33
L_barret33:
  s_waitcnt vmcnt(22)
  buffer_load_dwordx4 v12, s[16:19], s54 offen offset:2048 nt lds
  s_sub_u32 s56, s56, 1
  s_cbranch_scc1 L_bar34
L_barret34:
  s_waitcnt vmcnt(22)
  buffer_load_dwordx4 v13, s[16:19], s54 offen offset:3072 nt lds
  s_sub_u32 s56, s56, 1
  s_cbranch_scc1 L_bar35
L_barret35:
  s_add_u32 s54, s54, 16384
  s_bfe_u32 m0, s54, 1048578
  s_waitcnt vmcnt(22)
  buffer_load_dwordx4 v10, s[16:19], s54 offen offset:0 nt lds
  s_sub_u32 s56, s56, 1
  s_cbranch_scc1 L_bar36
L_barret36:
  s_waitcnt vmcnt(22)
  buffer_load_dwordx4 v11, s[16:19], s54 offen offset:1024 nt lds
  s_sub_u32 s56, s56, 1
  s_cbranch_scc1 L_bar37
L_barret37:
  s_waitcnt vmcnt(22)
  buffer_load_dwordx4 v12, s[16:19], s54 offen offset:2048 nt lds
  s_sub_u32 s56, s56, 1
  s_cbranch_scc1 L_bar38
L_barret38:
  s_waitcnt vmcnt(22)
  buffer_load_dwordx4 v13, s[16:19], s54 offen offset:3072 nt lds
  s_sub_u32 s56, s56, 1
  s_cbranch_scc1 L_bar39
L_barret39:
  s_add_u32 s54, s54, 16384
  s_bfe_u32 s52, s55, 1048578
  s_or_b32 m0, s52, 65536
  s_waitcnt vmcnt(22)
  buffer_load_dwordx4 v14, s[20:23], s55 offen offset:0 nt lds
  s_sub_u32 s56, s56, 1
  s_cbranch_scc1 L_bar40
L_barret40:
  s_waitcnt vmcnt(22)
  buffer_load_dwordx4 v15, s[20:23], s55 offen offset:1024 nt lds
  s_sub_u32 s56, s56, 1
  s_cbranch_scc1 L_bar41
L_barret41:
  s_waitcnt vmcnt(22)
  buffer_load_dwordx4 v16, s[20:23], s55 offen offset:2048 nt lds
  s_sub_u32 s56, s56, 1
  s_cbranch_scc1 L_bar42
L_barret42:
  s_waitcnt vmcnt(22)
  buffer_load_dwordx4 v17, s[20:23], s55 offen offset:3072 nt lds
  s_sub_u32 s56, s56, 1
  s_cbranch_scc1 L_bar43
L_barret43:
  s_add_u32 s55, s55, 16384
  s_bfe_u32 s52, s55, 1048578
  s_or_b32 m0, s52, 65536
  s_waitcnt vmcnt(22)
  buffer_load_dwordx4 v14, s[20:23], s55 offen offset:0 nt lds
  s_sub_u32 s56, s56, 1
  s_cbranch_scc1 L_bar44
L_barret44:
  s_waitcnt vmcnt(22)
  buffer_load_dwordx4 v15, s[20:23], s55 offen offset:1024 nt lds
  s_sub_u32 s56, s56, 1
  s_cbranch_scc1 L_bar45
L_barret45:
  s_waitcnt vmcnt(22)
  buffer_load_dwordx4 v16, s[20:23], s55 offen offset:2048 nt lds
  s_sub_u32 s56, s56, 1
  s_cbranch_scc1 L_bar46
L_barret46:
  s_waitcnt vmcnt(22)
  buffer_load_dwordx4 v17, s[20:23], s55 offen offset:3072 nt lds
  s_sub_u32 s56, s56, 1
  s_cbranch_scc1 L_bar47
L_barret47:
  s_add_u32 s55, s55, 16384
  s_bfe_u32 m0, s54, 1048578
  s_waitcnt vmcnt(22)
  buffer_load_dwordx4 v10, s[16:19], s54 offen offset:0 nt lds
  s_sub_u32 s56, s56, 1
  s_cbranch_scc1 L_bar48
L_barret48:
  s_waitcnt vmcnt(22)
  buffer_load_dwordx4 v11, s[16:19], s54 offen offset:1024 nt lds
  s_sub_u32 s56, s56, 1
  s_cbranch_scc1 L_bar49
L_barret49:
  s_waitcnt vmcnt(22)
  buffer_load_dwordx4 v12, s[16:19], s54 offen offset:2048 nt lds
  s_sub_u32 s56, s56, 1
  s_cbranch_scc1 L_bar50
L_barret50:
  s_waitcnt vmcnt(22)
  buffer_load_dwordx4 v13, s[16:19], s54 offen offset:3072 nt lds
  s_sub_u32 s56, s56, 1
  s_cbranch_scc1 L_bar51
L_barret51:
  s_add_u32 s54, s54, 16384
  s_bfe_u32 m0, s54, 1048578
  s_waitcnt vmcnt(20)
  buffer_load_dwordx4 v10, s[16:19], s54 offen offset:0 nt lds
  s_sub_u32 s56, s56, 1
  s_cbranch_scc1 L_bar52
L_barret52:
  s_waitcnt vmcnt(20)
  buffer_load_dwordx4 v11, s[16:19], s54 offen offset:1024 nt lds
  s_sub_u32 s56, s56, 1
  s_cbranch_scc1 L_bar53
L_barret53:
  s_waitcnt vmcnt(20)
  buffer_load_dwordx4 v12, s[16:19], s54 offen offset:2048 nt lds
  s_sub_u32 s56, s56, 1
  s_cbranch_scc1 L_bar54
L_barret54:
  s_waitcnt vmcnt(20)
  buffer_load_dwordx4 v13, s[16:19], s54 offen offset:3072 nt lds
  s_sub_u32 s56, s56, 1
  s_cbranch_scc1 L_bar55
L_barret55:
  s_add_u32 s54, s54, 16384
  s_bfe_u32 s52, s55, 1048578
  s_or_b32 m0, s52, 65536
  s_waitcnt vmcnt(20)
  buffer_load_dwordx4 v14, s[20:23], s55 offen offset:0 nt lds
  s_sub_u32 s56, s56, 1
  s_cbranch_scc1 L_bar56
L_barret56:
  s_waitcnt vmcnt(20)
  buffer_load_dwordx4 v15, s[20:23], s55 offen offset:1024 nt lds
  s_sub_u32 s56, s56, 1
  s_cbranch_scc1 L_bar57
L_barret57:
  s_waitcnt vmcnt(20)
  buffer_load_dwordx4 v16, s[20:23], s55 offen offset:2048 nt lds
  s_sub_u32 s56, s56, 1
  s_cbranch_scc1 L_bar58
L_barret58:
  s_waitcnt vmcnt(20)
  buffer_load_dwordx4 v17, s[20:23], s55 offen offset:3072 nt lds
  s_sub_u32 s56, s56, 1
  s_cbranch_scc1 L_bar59
L_barret59:
  s_add_u32 s55, s55, 16384
  s_bfe_u32 s52, s55, 1048578
  s_or_b32 m0, s52, 65536
  s_waitcnt vmcnt(20)
  buffer_load_dwordx4 v14, s[20:23], s55 offen offset:0 nt lds
  s_sub_u32 s56, s56, 1
  s_cbranch_scc1 L_bar60
L_barret60:
  s_waitcnt vmcnt(20)
  buffer_load_dwordx4 v15, s[20:23], s55 offen offset:1024 nt lds
  s_sub_u32 s56, s56, 1
  s_cbranch_scc1 L_bar61
L_barret61:
  s_waitcnt vmcnt(20)
  buffer_load_dwordx4 v16, s[20:23], s55 offen offset:2048 nt lds
  s_sub_u32 s56, s56, 1
  s_cbranch_scc1 L_bar62
L_barret62:
  s_waitcnt vmcnt(20)
  buffer_load_dwordx4 v17, s[20:23], s55 offen offset:3072 nt lds
  s_sub_u32 s56, s56, 1
  s_cbranch_scc1 L_bar63
L_barret63:
  s_add_u32 s55, s55, 16384
  s_cmp_lg_u32 s61, 30
  s_cbranch_scc1 L_ldloop
  s_branch L_ldtail
L_lv2:
  s_bfe_u32 m0, s54, 1048578
  s_waitcnt vmcnt(24)
  buffer_load_dwordx4 v10, s[16:19], s54 offen offset:0 nt lds
  s_sub_u32 s56, s56, 1
  s_cbranch_scc1 L_bar64
L_barret64:
  s_waitcnt vmcnt(24)
  buffer_load_dwordx4 v11, s[16:19], s54 offen offset:1024 nt lds
  s_sub_u32 s56, s56, 1
  s_cbranch_scc1 L_bar65
L_barret65:
  s_waitcnt vmcnt(24)
  buffer_load_dwordx4 v12, s[16:19], s54 offen offset:2048 nt lds
  s_sub_u32 s56, s56, 1
  s_cbranch_scc1 L_bar66
L_barret66:
  s_waitcnt vmcnt(24)
  buffer_load_dwordx4 v13, s[16:19], s54 offen offset:3072 nt lds
  s_sub_u32 s56, s56, 1
  s_cbranch_scc1 L_bar67
L_barret67:
  s_add_u32 s54, s54, 16384
  s_bfe_u32 m0, s54, 1048578
  s_waitcnt vmcnt(24)
  buffer_load_dwordx4 v10, s[16:19], s54 offen offset:0 nt lds
  s_sub_u32 s56, s56, 1
  s_cbranch_scc1 L_bar68
L_barret68:
  s_waitcnt vmcnt(24)
  buffer_load_dwordx4 v11, s[16:19], s54 offen offset:1024 nt lds
  s_sub_u32 s56, s56, 1
  s_cbranch_scc1 L_bar69
L_barret69:
  s_waitcnt vmcnt(24)
  buffer_load_dwordx4 v12, s[16:19], s54 offen offset:2048 nt lds
  s_sub_u32 s56, s56, 1
  s_cbranch_scc1 L_bar70
L_barret70:
  s_waitcnt vmcnt(24)
  buffer_load_dwordx4 v13, s[16:19], s54 offen offset:3072 nt lds
  s_sub_u32 s56, s56, 1
  s_cbranch_scc1 L_bar71
L_barret71:
  s_add_u32 s54, s54, 16384
  s_bfe_u32 s52, s55, 1048578
  s_or_b32 m0, s52, 65536
  s_waitcnt vmcnt(24)
  buffer_load_dwordx4 v14, s[20:23], s55 offen offset:0 nt lds
  s_sub_u32 s56, s56, 1
  s_cbranch_scc1 L_bar72
L_barret72:
  s_waitcnt vmcnt(24)
  buffer_load_dwordx4 v15, s[20:23], s55 offen offset:1024 nt lds
  s_sub_u32 s56, s56, 1
  s_cbranch_scc1 L_bar73
L_barret73:
  s_waitcnt vmcnt(24)
  buffer_load_dwordx4 v16, s[20:23], s55 offen offset:2048 nt lds
  s_sub_u32 s56, s56, 1
  s_cbranch_scc1 L_bar74
L_barret74:
  s_waitcnt vmcnt(24)
  buffer_load_dwordx4 v17, s[20:23], s55 offen offset:3072 nt lds
  s_sub_u32 s56, s56, 1
  s_cbranch_scc1 L_bar75
L_barret75:
  s_add_u32 s55, s55, 16384
  s_bfe_u32 s52, s55, 1048578
  s_or_b32 m0, s52, 65536
  s_waitcnt vmcnt(24)
  buffer_load_dwordx4 v14, s[20:23], s55 offen offset:0 nt lds
  s_sub_u32 s56, s56, 1
  s_cbranch_scc1 L_bar76
L_barret76:
  s_waitcnt vmcnt(24)
  buffer_load_dwordx4 v15, s[20:23], s55 offen offset:1024 nt lds
  s_sub_u32 s56, s56, 1
  s_cbranch_scc1 L_bar77
L_barret77:
  s_waitcnt vmcnt(24)
  buffer_load_dwordx4 v16, s[20:23], s55 offen offset:2048 nt lds
  s_sub_u32 s56, s56, 1
  s_cbranch_scc1 L_bar78
L_barret78:
  s_waitcnt vmcnt(24)
  buffer_load_dwordx4 v17, s[20:23], s55 offen offset:3072 nt lds
  s_sub_u32 s56, s56, 1
  s_cbranch_scc1 L_bar79
L_barret79:
  s_add_u32 s55, s55, 16384
  s_bfe_u32 m0, s54, 1048578
  s_waitcnt vmcnt(24)
  buffer_load_dwordx4 v10, s[16:19], s54 offen offset:0 nt lds
  s_sub_u32 s56, s56, 1
  s_cbranch_scc1 L_bar80
L_barret80:
  s_waitcnt vmcnt(24)
  buffer_load_dwordx4 v11, s[16:19], s54 offen offset:1024 nt lds
  s_sub_u32 s56, s56, 1
  s_cbranch_scc1 L_bar81
L_barret81:
  s_waitcnt vmcnt(24)
  buffer_load_dwordx4 v12, s[16:19], s54 offen offset:2048 nt lds
  s_sub_u32 s56, s56, 1
  s_cbranch_scc1 L_bar82
L_barret82:
  s_waitcnt vmcnt(24)
  buffer_load_dwordx4 v13, s[16:19], s54 offen offset:3072 nt lds
  s_sub_u32 s56, s56, 1
  s_cbranch_scc1 L_bar83
L_barret83:
  s_add_u32 s54, s54, 16384
  s_bfe_u32 m0, s54, 1048578
  s_waitcnt vmcnt(24)
  buffer_load_dwordx4 v10, s[16:19], s54 offen offset:0 nt lds
  s_sub_u32 s56, s56, 1
  s_cbranch_scc1 L_bar84
L_barret84:
  s_waitcnt vmcnt(24)
  buffer_load_dwordx4 v11, s[16:19], s54 offen offset:1024 nt lds
  s_sub_u32 s56, s56, 1
  s_cbranch_scc1 L_bar85
L_barret85:
  s_waitcnt vmcnt(22)
  buffer_load_dwordx4 v12, s[16:19], s54 offen offset:2048 nt lds
  s_sub_u32 s56, s56, 1
  s_cbranch_scc1 L_bar86
L_barret86:
  s_waitcnt vmcnt(22)
  buffer_load_dwordx4 v13, s[16:19], s54 offen offset:3072 nt lds
  s_sub_u32 s56, s56, 1
  s_cbranch_scc1 L_bar87
L_barret87:
  s_add_u32 s54, s54, 16384
  s_bfe_u32 s52, s55, 1048578
  s_or_b32 m0, s52, 65536
  s_waitcnt vmcnt(22)
  buffer_load_dwordx4 v14, s[20:23], s55 offen offset:0 nt lds
  s_sub_u32 s56, s56, 1
  s_cbranch_scc1 L_bar88
L_barret88:
  s_waitcnt vmcnt(22)
  buffer_load_dwordx4 v15, s[20:23], s55 offen offset:1024 nt lds
  s_sub_u32 s56, s56, 1
  s_cbranch_scc1 L_bar89
L_barret89:
  s_waitcnt vmcnt(22)
  buffer_load_dwordx4 v16, s[20:23], s55 offen offset:2048 nt lds
  s_sub_u32 s56, s56, 1
  s_cbranch_scc1 L_bar90
L_barret90:
  s_waitcnt vmcnt(22)
  buffer_load_dwordx4 v17, s[20:23], s55 offen offset:3072 nt lds
  s_sub_u32 s56, s56, 1
  s_cbranch_scc1 L_bar91
L_barret91:
  s_add_u32 s55, s55, 16384
  s_bfe_u32 s52, s55, 1048578
  s_or_b32 m0, s52, 65536
  s_waitcnt vmcnt(22)
  buffer_load_dwordx4 v14, s[20:23], s55 offen offset:0 nt lds
  s_sub_u32 s56, s56, 1
  s_cbranch_scc1 L_bar92
L_barret92:
  s_waitcnt vmcnt(22)
  buffer_load_dwordx4 v15, s[20:23], s55 offen offset:1024 nt lds
  s_sub_u32 s56, s56, 1
  s_cbranch_scc1 L_bar93
L_barret93:
  s_waitcnt vmcnt(22)
  buffer_load_dwordx4 v16, s[20:23], s55 offen offset:2048 nt lds
  s_sub_u32 s56, s56, 1
  s_cbranch_scc1 L_bar94
L_barret94:
  s_waitcnt vmcnt(22)
  buffer_load_dwordx4 v17, s[20:23], s55 offen offset:3072 nt lds
  s_sub_u32 s56, s56, 1
  s_cbranch_scc1 L_bar95
L_barret95:
  s_add_u32 s55, s55, 16384
  s_cmp_lg_u32 s61, 30
  s_cbranch_scc1 L_ldloop
  s_branch L_ldtail
.p2align 6
L_barfn:
  s_barrier
  s_and_b32 s56, s58, 15
  s_lshr_b64 s[58:59], s[58:59], 4
  s_add_u32 s57, s57, 1
  s_cmp_gt_u32 s57, s62
  s_addc_u32 s56, s56, 14
  s_setpc_b64 s[76:77]
L_bar0:
  s_call_b64 s[76:77], L_barfn
  s_branch L_barret0
L_bar1:
  s_call_b64 s[76:77], L_barfn
  s_branch L_barret1
L_bar2:
  s_call_b64 s[76:77], L_barfn
  s_branch L_barret2
L_bar3:
  s_call_b64 s[76:77], L_barfn
  s_branch L_barret3
L_bar4:
  s_call_b64 s[76:77], L_barfn
  s_branch L_barret4
L_bar5:
  s_call_b64 s[76:77], L_barfn
  s_branch L_barret5
L_bar6:
  s_call_b64 s[76:77], L_barfn
  s_branch L_barret6
L_bar7:
  s_call_b64 s[76:77], L_barfn
  s_branch L_barret7
L_bar8:
  s_call_b64 s[76:77], L_barfn
  s_branch L_barret8
L_bar9:
  s_call_b64 s[76:77], L_barfn
  s_branch L_barret9
L_bar10:
  s_call_b64 s[76:77], L_barfn
  s_branch L_barret10
L_bar11:
  s_call_b64 s[76:77], L_barfn
  s_branch L_barret11
L_bar12:
  s_call_b64 s[76:77], L_barfn
  s_branch L_barret12
L_bar13:
  s_call_b64 s[76:77], L_barfn
  s_branch L_barret13
L_bar14:
  s_call_b64 s[76:77], L_barfn
  s_branch L_barret14
L_bar15:
  s_call_b64 s[76:77], L_barfn
  s_branch L_barret15
L_bar16:
  s_call_b64 s[76:77], L_barfn
  s_branch L_barret16
L_bar17:
  s_call_b64 s[76:77], L_barfn
  s_branch L_barret17
L_bar18:
  s_call_b64 s[76:77], L_barfn
  s_branch L_barret18
L_bar19:
  s_call_b64 s[76:77], L_barfn
  s_branch L_barret19
L_bar20:
  s_call_b64 s[76:77], L_barfn
  s_branch L_barret20
L_bar21:
  s_call_b64 s[76:77], L_barfn
  s_branch L_barret21
L_bar22:
  s_call_b64 s[76:77], L_barfn
  s_branch L_barret22
L_bar23:
  s_call_b64 s[76:77], L_barfn
  s_branch L_barret23
L_bar24:
  s_call_b64 s[76:77], L_barfn
  s_branch L_barret24
L_bar25:
  s_call_b64 s[76:77], L_barfn
  s_branch L_barret25
L_bar26:
  s_call_b64 s[76:77], L_barfn
  s_branch L_barret26
L_bar27:
  s_call_b64 s[76:77], L_barfn
  s_branch L_barret27
L_bar28:
  s_call_b64 s[76:77], L_barfn
  s_branch L_barret28
L_bar29:
  s_call_b64 s[76:77], L_barfn
  s_branch L_barret29
L_bar30:
  s_call_b64 s[76:77], L_barfn
  s_branch L_barret30
L_bar31:
  s_call_b64 s[76:77], L_barfn
  s_branch L_barret31
L_bar32:
  s_call_b64 s[76:77], L_barfn
  s_branch L_barret32
L_bar33:
  s_call_b64 s[76:77], L_barfn
  s_branch L_barret33
L_bar34:
  s_call_b64 s[76:77], L_barfn
  s_branch L_barret34
L_bar35:
  s_call_b64 s[76:77], L_barfn
  s_branch L_barret35
L_bar36:
  s_call_b64 s[76:77], L_barfn
  s_branch L_barret36
L_bar37:
  s_call_b64 s[76:77], L_barfn
  s_branch L_barret37
L_bar38:
  s_call_b64 s[76:77], L_barfn
  s_branch L_barret38
L_bar39:
  s_call_b64 s[76:77], L_barfn
  s_branch L_barret39
L_bar40:
  s_call_b64 s[76:77], L_barfn
  s_branch L_barret40
L_bar41:
  s_call_b64 s[76:77], L_barfn
  s_branch L_barret41
L_bar42:
  s_call_b64 s[76:77], L_barfn
  s_branch L_barret42
L_bar43:
  s_call_b64 s[76:77], L_barfn
  s_branch L_barret43
L_bar44:
  s_call_b64 s[76:77], L_barfn
  s_branch L_barret44
L_bar45:
  s_call_b64 s[76:77], L_barfn
  s_branch L_barret45
L_bar46:
  s_call_b64 s[76:77], L_barfn
  s_branch L_barret46
L_bar47:
  s_call_b64 s[76:77], L_barfn
  s_branch L_barret47
L_bar48:
  s_call_b64 s[76:77], L_barfn
  s_branch L_barret48
L_bar49:
  s_call_b64 s[76:77], L_barfn
  s_branch L_barret49
L_bar50:
  s_call_b64 s[76:77], L_barfn
  s_branch L_barret50
L_bar51:
  s_call_b64 s[76:77], L_barfn
  s_branch L_barret51
L_bar52:
  s_call_b64 s[76:77], L_barfn
  s_branch L_barret52
L_bar53:
  s_call_b64 s[76:77], L_barfn
  s_branch L_barret53
L_bar54:
  s_call_b64 s[76:77], L_barfn
  s_branch L_barret54
L_bar55:
  s_call_b64 s[76:77], L_barfn
  s_branch L_barret55
L_bar56:
  s_call_b64 s[76:77], L_barfn
  s_branch L_barret56
L_bar57:
  s_call_b64 s[76:77], L_barfn
  s_branch L_barret57
L_bar58:
  s_call_b64 s[76:77], L_barfn
  s_branch L_barret58
L_bar59:
  s_call_b64 s[76:77], L_barfn
  s_branch L_barret59
L_bar60:
  s_call_b64 s[76:77], L_barfn
  s_branch L_barret60
L_bar61:
  s_call_b64 s[76:77], L_barfn
  s_branch L_barret61
L_bar62:
  s_call_b64 s[76:77], L_barfn
  s_branch L_barret62
L_bar63:
  s_call_b64 s[76:77], L_barfn
  s_branch L_barret63
L_bar64:
  s_call_b64 s[76:77], L_barfn
  s_branch L_barret64
L_bar65:
  s_call_b64 s[76:77], L_barfn
  s_branch L_barret65
L_bar66:
  s_call_b64 s[76:77], L_barfn
  s_branch L_barret66
L_bar67:
  s_call_b64 s[76:77], L_barfn
  s_branch L_barret67
L_bar68:
  s_call_b64 s[76:77], L_barfn
  s_branch L_barret68
L_bar69:
  s_call_b64 s[76:77], L_barfn
  s_branch L_barret69
L_bar70:
  s_call_b64 s[76:77], L_barfn
  s_branch L_barret70
L_bar71:
  s_call_b64 s[76:77], L_barfn
  s_branch L_barret71
L_bar72:
  s_call_b64 s[76:77], L_barfn
  s_branch L_barret72
L_bar73:
  s_call_b64 s[76:77], L_barfn
  s_branch L_barret73
L_bar74:
  s_call_b64 s[76:77], L_barfn
  s_branch L_barret74
L_bar75:
  s_call_b64 s[76:77], L_barfn
  s_branch L_barret75
L_bar76:
  s_call_b64 s[76:77], L_barfn
  s_branch L_barret76
L_bar77:
  s_call_b64 s[76:77], L_barfn
  s_branch L_barret77
L_bar78:
  s_call_b64 s[76:77], L_barfn
  s_branch L_barret78
L_bar79:
  s_call_b64 s[76:77], L_barfn
  s_branch L_barret79
L_bar80:
  s_call_b64 s[76:77], L_barfn
  s_branch L_barret80
L_bar81:
  s_call_b64 s[76:77], L_barfn
  s_branch L_barret81
L_bar82:
  s_call_b64 s[76:77], L_barfn
  s_branch L_barret82
L_bar83:
  s_call_b64 s[76:77], L_barfn
  s_branch L_barret83
L_bar84:
  s_call_b64 s[76:77], L_barfn
  s_branch L_barret84
L_bar85:
  s_call_b64 s[76:77], L_barfn
  s_branch L_barret85
L_bar86:
  s_call_b64 s[76:77], L_barfn
  s_branch L_barret86
L_bar87:
  s_call_b64 s[76:77], L_barfn
  s_branch L_barret87
L_bar88:
  s_call_b64 s[76:77], L_barfn
  s_branch L_barret88
L_bar89:
  s_call_b64 s[76:77], L_barfn
  s_branch L_barret89
L_bar90:
  s_call_b64 s[76:77], L_barfn
  s_branch L_barret90
L_bar91:
  s_call_b64 s[76:77], L_barfn
  s_branch L_barret91
L_bar92:
  s_call_b64 s[76:77], L_barfn
  s_branch L_barret92
L_bar93:
  s_call_b64 s[76:77], L_barfn
  s_branch L_barret93
L_bar94:
  s_call_b64 s[76:77], L_barfn
  s_branch L_barret94
L_bar95:
  s_call_b64 s[76:77], L_barfn
  s_branch L_barret95
.p2align 6
L_cons:
  s_sub_u32 s42, s3, 1
  s_lshl_b32 s64, s40, 2
  s_add_u32 s51, s64, s42
  s_lshl_b32 s52, s51, 13
  v_and_b32 v4, 15, v0
  v_lshrrev_b32 v5, 4, v0
  s_mov_b32 s27, 0x20000
  s_movk_i32 s53, 0x1000
  s_and_b32 s50, s40, 7
  s_lshl_b32 s50, s50, 20
  s_lshr_b32 s51, s40, 3
  s_lshl_b32 s51, s51, 17
  s_add_u32 s50, s50, s51
  s_waitcnt lgkmcnt(0)
  s_add_u32 s32, s14, s50
  s_addc_u32 s33, s15, 0
  s_mov_b32 s34, 131072
  s_mov_b32 s35, 0x20000
  s_add_u32 s28, s10, s52
  s_addc_u32 s29, s11, 0
  s_mov_b32 s30, 8192
  s_mov_b32 s31, 0x20000
  s_lshl_b32 s62, s42, 7
  s_add_u32 s62, s62, 69632
  s_lshl_b32 s63, s41, 2
  s_add_u32 s63, s63, s62
  v_mov_b32 v6, 0
  s_mov_b64 exec, 1
  buffer_store_dword v6, off, s[32:35], s63
  s_add_u32 s24, s14, 114688
  s_addc_u32 s25, s15, 0
  s_mov_b32 s26, 8390656
  s_and_b32 s51, s2, 7
  s_mul_i32 s51, s51, 1048832
  s_lshr_b32 s50, s2, 3
  s_lshl_b32 s50, s50, 2
  s_add_u32 s51, s51, s50
  buffer_store_dword v6, off, s[24:27], s51
  s_mov_b64 exec, -1
  s_lshl_b32 s57, s41, 2
  s_add_u32 s57, s57, s42
  s_mul_i32 s57, s57, 4352
  v_xor_b32 v6, v4, v5
  v_lshlrev_b32 v6, 4, v6
  v_lshl_add_u32 v12, v4, 8, v6
  v_xor_b32 v13, 64, v12
  v_xor_b32 v14, 128, v12
  v_xor_b32 v15, 192, v12
  v_lshrrev_b32 v6, 2, v0
  v_lshlrev_b32 v7, 8, v6
  v_and_b32 v6, 7, v6
  s_lshl_b32 s52, s41, 1
  s_and_b32 s52, s52, 4
  v_xor_b32 v6, s52, v6
  v_lshl_add_u32 v7, v6, 5, v7
  v_and_b32 v6, 3, v0
  v_lshl_add_u32 v7, v6, 3, v7
  v_lshlrev_b32 v9, 2, v6
  v_add_u32 v16, 65536, v7
  v_xor_b32 v17, 32, v16
  v_xor_b32 v18, 64, v16
  v_xor_b32 v19, 96, v16
  v_xor_b32 v20, 128, v16
  v_xor_b32 v21, 160, v16
  v_xor_b32 v22, 192, v16
  v_xor_b32 v23, 224, v16
  v_cmp_eq_u32 vcc, 0, v6
  v_mov_b32 v7, 0x3f803f80
  v_lshlrev_b32 v8, 4, v0
  v_cndmask_b32 v192, 0, v7, vcc
  v_cndmask_b32 v193, 0, v7, vcc
  v_cndmask_b32 v194, 0, v7, vcc
  v_cndmask_b32 v195, 0, v7, vcc
  s_mov_b32 s44, 0x3e0293ee
  s_mov_b32 s45, 0x4b800000
  v_mov_b64 v[64:65], 0
  v_mov_b64 v[66:67], 0
  v_mov_b64 v[68:69], 0
  v_mov_b64 v[70:71], 0
  v_mov_b64 v[72:73], 0
  v_mov_b64 v[74:75], 0
  v_mov_b64 v[76:77], 0
  v_mov_b64 v[78:79], 0
  v_mov_b64 v[80:81], 0
  v_mov_b64 v[82:83], 0
  v_mov_b64 v[84:85], 0
  v_mov_b64 v[86:87], 0
  v_mov_b64 v[88:89], 0
  v_mov_b64 v[90:91], 0
  v_mov_b64 v[92:93], 0
  v_mov_b64 v[94:95], 0
  v_mov_b64 v[96:97], 0
  v_mov_b64 v[98:99], 0
  v_mov_b64 v[100:101], 0
  v_mov_b64 v[102:103], 0
  v_mov_b64 v[104:105], 0
  v_mov_b64 v[106:107], 0
  v_mov_b64 v[108:109], 0
  v_mov_b64 v[110:111], 0
  v_mov_b64 v[112:113], 0
  v_mov_b64 v[114:115], 0
  v_mov_b64 v[116:117], 0
  v_mov_b64 v[118:119], 0
  v_mov_b64 v[120:121], 0
  v_mov_b64 v[122:123], 0
  v_mov_b64 v[124:125], 0
  v_mov_b64 v[126:127], 0
  s_xor_b32 s51, s41, 1
  s_lshl_b32 s51, s51, 2
  s_add_u32 s51, s51, s42
  s_mul_i32 s51, s51, 4352
  s_add_u32 s59, s51, 4096
  s_add_u32 s54, s51, 0
  s_xor_b32 s51, s41, 2
  s_lshl_b32 s51, s51, 2
  s_add_u32 s51, s51, s42
  s_mul_i32 s51, s51, 4352
  s_add_u32 s60, s51, 4096
  s_add_u32 s55, s51, 0
  s_xor_b32 s51, s41, 3
  s_lshl_b32 s51, s51, 2
  s_add_u32 s51, s51, s42
  s_mul_i32 s51, s51, 4352
  s_add_u32 s61, s51, 4096
  s_add_u32 s56, s51, 2048
  s_add_u32 s58, s57, 4096
  v_and_b32 v206, 0xf0, v8
  v_and_b32 v6, 15, v0
  v_lshlrev_b32 v10, 8, v6
  v_bfe_u32 v6, v0, 4, 1
  v_lshl_add_u32 v10, v6, 5, v10
  v_lshrrev_b32 v6, 5, v0
  v_lshl_add_u32 v10, v6, 4, v10
  s_and_b32 s52, s41, 1
  s_lshl_b32 s47, s52, 12
  s_and_b32 s52, s41, 2
  s_lshl_b32 s52, s52, 6
  s_add_u32 s52, s52, s47
  v_add_u32 v10, s52, v10
  v_lshrrev_b32 v6, 3, v0
  v_and_b32 v204, 0x70, v8
  v_lshl_add_u32 v204, v6, 8, v204
  v_add_u32 v204, s52, v204
  v_xor_b32 v205, 0x1000, v204
  s_lshl_b32 s52, s42, 13
  s_add_u32 s52, s52, 98304
  s_add_u32 s52, s52, s47
  v_add_u32 v24, s52, v12
  v_add_u32 v25, s52, v13
  v_add_u32 v26, s52, v14
  v_add_u32 v27, s52, v15
  v_xor_b32 v28, 0x1000, v24
  v_xor_b32 v29, 0x1000, v25
  v_xor_b32 v30, 0x1000, v26
  v_xor_b32 v31, 0x1000, v27
  s_waitcnt vmcnt(0)
  s_barrier
  s_cmp_lg_u32 s42, 0
  s_cbranch_scc1 L_nohello
  s_mov_b32 s36, s12
  s_mov_b32 s37, s13
  s_mov_b32 s38, 256
  s_mov_b32 s39, 0x20000
  s_getreg_b32 s52, hwreg(HW_REG_XCC_ID, 0, 3)
  s_or_b32 s52, s52, 0x80
  v_mov_b32 v6, s52
  s_add_u32 s52, s64, s41
  s_mov_b64 exec, 1
  buffer_store_byte v6, off, s[36:39], s52
  s_mov_b64 exec, -1
L_nohello:
  ds_read_b128 v[208:211], v24 offset:0
  ds_read_b128 v[212:215], v25 offset:0
  ds_read_b128 v[216:219], v26 offset:0
  ds_read_b128 v[220:223], v27 offset:0
  ds_read_b128 v[224:227], v28 offset:0
  ds_read_b128 v[228:231], v29 offset:0
  ds_read_b128 v[232:235], v30 offset:0
  ds_read_b128 v[236:239], v31 offset:0
  s_waitcnt lgkmcnt(0)
  v_mov_b32 v6, s44
  v_lshlrev_b32 v128, 16, v208
  v_and_b32 v129, 0xffff0000, v208
  v_pk_mul_f32 v[128:129], v[128:129], v[6:7] op_sel_hi:[1,0]
  v_lshlrev_b32 v130, 16, v209
  v_and_b32 v131, 0xffff0000, v209
  v_pk_mul_f32 v[130:131], v[130:131], v[6:7] op_sel_hi:[1,0]
  v_cvt_pk_bf16_f32 v208, v128, v129
  v_lshlrev_b32 v132, 16, v210
  v_and_b32 v133, 0xffff0000, v210
  v_pk_mul_f32 v[132:133], v[132:133], v[6:7] op_sel_hi:[1,0]
  v_cvt_pk_bf16_f32 v209, v130, v131
  v_lshlrev_b32 v134, 16, v211
  v_and_b32 v135, 0xffff0000, v211
  v_pk_mul_f32 v[134:135], v[134:135], v[6:7] op_sel_hi:[1,0]
  v_cvt_pk_bf16_f32 v210, v132, v133
  v_lshlrev_b32 v128, 16, v212
  v_and_b32 v129, 0xffff0000, v212
  v_pk_mul_f32 v[128:129], v[128:129], v[6:7] op_sel_hi:[1,0]
  v_cvt_pk_bf16_f32 v211, v134, v135
  v_lshlrev_b32 v130, 16, v213
  v_and_b32 v131, 0xffff0000, v213
  v_pk_mul_f32 v[130:131], v[130:131], v[6:7] op_sel_hi:[1,0]
  v_cvt_pk_bf16_f32 v212, v128, v129
  v_lshlrev_b32 v132, 16, v214
  v_and_b32 v133, 0xffff0000, v214
  v_pk_mul_f32 v[132:133], v[132:133], v[6:7] op_sel_hi:[1,0]
  v_cvt_pk_bf16_f32 v213, v130, v131
  v_lshlrev_b32 v134, 16, v215
  v_and_b32 v135, 0xffff0000, v215
  v_pk_mul_f32 v[134:135], v[134:135], v[6:7] op_sel_hi:[1,0]
  v_cvt_pk_bf16_f32 v214, v132, v133
  v_lshlrev_b32 v128, 16, v216
  v_and_b32 v129, 0xffff0000, v216
  v_pk_mul_f32 v[128:129], v[128:129], v[6:7] op_sel_hi:[1,0]
  v_cvt_pk_bf16_f32 v215, v134, v135
  v_lshlrev_b32 v130, 16, v217
  v_and_b32 v131, 0xffff0000, v217
  v_pk_mul_f32 v[130:131], v[130:131], v[6:7] op_sel_hi:[1,0]
  v_cvt_pk_bf16_f32 v216, v128, v129
  v_lshlrev_b32 v132, 16, v218
  v_and_b32 v133, 0xffff0000, v218
  v_pk_mul_f32 v[132:133], v[132:133], v[6:7] op_sel_hi:[1,0]
  v_cvt_pk_bf16_f32 v217, v130, v131
  v_lshlrev_b32 v134, 16, v219
  v_and_b32 v135, 0xffff0000, v219
  v_pk_mul_f32 v[134:135], v[134:135], v[6:7] op_sel_hi:[1,0]
  v_cvt_pk_bf16_f32 v218, v132, v133
  v_lshlrev_b32 v128, 16, v220
  v_and_b32 v129, 0xffff0000, v220
  v_pk_mul_f32 v[128:129], v[128:129], v[6:7] op_sel_hi:[1,0]
  v_cvt_pk_bf16_f32 v219, v134, v135
  v_lshlrev_b32 v130, 16, v221
  v_and_b32 v131, 0xffff0000, v221
  v_pk_mul_f32 v[130:131], v[130:131], v[6:7] op_sel_hi:[1,0]
  v_cvt_pk_bf16_f32 v220, v128, v129
  v_lshlrev_b32 v132, 16, v222
  v_and_b32 v133, 0xffff0000, v222
  v_pk_mul_f32 v[132:133], v[132:133], v[6:7] op_sel_hi:[1,0]
  v_cvt_pk_bf16_f32 v221, v130, v131
  v_lshlrev_b32 v134, 16, v223
  v_and_b32 v135, 0xffff0000, v223
  v_pk_mul_f32 v[134:135], v[134:135], v[6:7] op_sel_hi:[1,0]
  v_cvt_pk_bf16_f32 v222, v132, v133
  v_lshlrev_b32 v128, 16, v224
  v_and_b32 v129, 0xffff0000, v224
  v_pk_mul_f32 v[128:129], v[128:129], v[6:7] op_sel_hi:[1,0]
  v_cvt_pk_bf16_f32 v223, v134, v135
  v_lshlrev_b32 v130, 16, v225
  v_and_b32 v131, 0xffff0000, v225
  v_pk_mul_f32 v[130:131], v[130:131], v[6:7] op_sel_hi:[1,0]
  v_cvt_pk_bf16_f32 v224, v128, v129
  v_lshlrev_b32 v132, 16, v226
  v_and_b32 v133, 0xffff0000, v226
  v_pk_mul_f32 v[132:133], v[132:133], v[6:7] op_sel_hi:[1,0]
  v_cvt_pk_bf16_f32 v225, v130, v131
  v_lshlrev_b32 v134, 16, v227
  v_and_b32 v135, 0xffff0000, v227
  v_pk_mul_f32 v[134:135], v[134:135], v[6:7] op_sel_hi:[1,0]
  v_cvt_pk_bf16_f32 v226, v132, v133
  v_lshlrev_b32 v128, 16, v228
  v_and_b32 v129, 0xffff0000, v228
  v_pk_mul_f32 v[128:129], v[128:129], v[6:7] op_sel_hi:[1,0]
  v_cvt_pk_bf16_f32 v227, v134, v135
  v_lshlrev_b32 v130, 16, v229
  v_and_b32 v131, 0xffff0000, v229
  v_pk_mul_f32 v[130:131], v[130:131], v[6:7] op_sel_hi:[1,0]
  v_cvt_pk_bf16_f32 v228, v128, v129
  v_lshlrev_b32 v132, 16, v230
  v_and_b32 v133, 0xffff0000, v230
  v_pk_mul_f32 v[132:133], v[132:133], v[6:7] op_sel_hi:[1,0]
  v_cvt_pk_bf16_f32 v229, v130, v131
  v_lshlrev_b32 v134, 16, v231
  v_and_b32 v135, 0xffff0000, v231
  v_pk_mul_f32 v[134:135], v[134:135], v[6:7] op_sel_hi:[1,0]
  v_cvt_pk_bf16_f32 v230, v132, v133
  v_lshlrev_b32 v128, 16, v232
  v_and_b32 v129, 0xffff0000, v232
  v_pk_mul_f32 v[128:129], v[128:129], v[6:7] op_sel_hi:[1,0]
  v_cvt_pk_bf16_f32 v231, v134, v135
  v_lshlrev_b32 v130, 16, v233
  v_and_b32 v131, 0xffff0000, v233
  v_pk_mul_f32 v[130:131], v[130:131], v[6:7] op_sel_hi:[1,0]
  v_cvt_pk_bf16_f32 v232, v128, v129
  v_lshlrev_b32 v132, 16, v234
  v_and_b32 v133, 0xffff0000, v234
  v_pk_mul_f32 v[132:133], v[132:133], v[6:7] op_sel_hi:[1,0]
  v_cvt_pk_bf16_f32 v233, v130, v131
  v_lshlrev_b32 v134, 16, v235
  v_and_b32 v135, 0xffff0000, v235
  v_pk_mul_f32 v[134:135], v[134:135], v[6:7] op_sel_hi:[1,0]
  v_cvt_pk_bf16_f32 v234, v132, v133
  v_lshlrev_b32 v128, 16, v236
  v_and_b32 v129, 0xffff0000, v236
  v_pk_mul_f32 v[128:129], v[128:129], v[6:7] op_sel_hi:[1,0]
  v_cvt_pk_bf16_f32 v235, v134, v135
  v_lshlrev_b32 v130, 16, v237
  v_and_b32 v131, 0xffff0000, v237
  v_pk_mul_f32 v[130:131], v[130:131], v[6:7] op_sel_hi:[1,0]
  v_cvt_pk_bf16_f32 v236, v128, v129
  v_lshlrev_b32 v132, 16, v238
  v_and_b32 v133, 0xffff0000, v238
  v_pk_mul_f32 v[132:133], v[132:133], v[6:7] op_sel_hi:[1,0]
  v_cvt_pk_bf16_f32 v237, v130, v131
  v_lshlrev_b32 v134, 16, v239
  v_and_b32 v135, 0xffff0000, v239
  v_pk_mul_f32 v[134:135], v[134:135], v[6:7] op_sel_hi:[1,0]
  v_cvt_pk_bf16_f32 v238, v132, v133
  v_cvt_pk_bf16_f32 v239, v134, v135
  s_barrier
  ds_read_b128 v[32:35], v12 offset:0
  ds_read_b128 v[36:39], v13 offset:0
  ds_read_b128 v[40:43], v14 offset:0
  ds_read_b128 v[44:47], v15 offset:0
  ds_read_b128 v[48:51], v12 offset:4096
  ds_read_b128 v[52:55], v13 offset:4096
  ds_read_b128 v[56:59], v14 offset:4096
  ds_read_b128 v[60:63], v15 offset:4096
  s_waitcnt lgkmcnt(7)
  v_mfma_f32_16x16x32_bf16 v[128:131], v[32:35], v[208:211], 0
  s_waitcnt lgkmcnt(6)
  v_mfma_f32_16x16x32_bf16 v[128:131], v[36:39], v[212:215], v[128:131]
  s_waitcnt lgkmcnt(5)
  v_mfma_f32_16x16x32_bf16 v[128:131], v[40:43], v[216:219], v[128:131]
  s_waitcnt lgkmcnt(4)
  v_mfma_f32_16x16x32_bf16 v[128:131], v[44:47], v[220:223], v[128:131]
  v_mfma_f32_16x16x32_bf16 v[132:135], v[32:35], v[224:227], 0
  v_mfma_f32_16x16x32_bf16 v[132:135], v[36:39], v[228:231], v[132:135]
  v_mfma_f32_16x16x32_bf16 v[132:135], v[40:43], v[232:235], v[132:135]
  v_mfma_f32_16x16x32_bf16 v[132:135], v[44:47], v[236:239], v[132:135]
  ds_read_b128 v[32:35], v12 offset:8192
  ds_read_b128 v[36:39], v13 offset:8192
  ds_read_b128 v[40:43], v14 offset:8192
  ds_read_b128 v[44:47], v15 offset:8192
  s_waitcnt lgkmcnt(7)
  v_mfma_f32_16x16x32_bf16 v[136:139], v[48:51], v[208:211], 0
  s_waitcnt lgkmcnt(6)
  v_mfma_f32_16x16x32_bf16 v[136:139], v[52:55], v[212:215], v[136:139]
  s_waitcnt lgkmcnt(5)
  v_mfma_f32_16x16x32_bf16 v[136:139], v[56:59], v[216:219], v[136:139]
  s_waitcnt lgkmcnt(4)
  v_mfma_f32_16x16x32_bf16 v[136:139], v[60:63], v[220:223], v[136:139]
  v_mfma_f32_16x16x32_bf16 v[140:143], v[48:51], v[224:227], 0
  v_mfma_f32_16x16x32_bf16 v[140:143], v[52:55], v[228:231], v[140:143]
  v_mfma_f32_16x16x32_bf16 v[140:143], v[56:59], v[232:235], v[140:143]
  v_mfma_f32_16x16x32_bf16 v[140:143], v[60:63], v[236:239], v[140:143]
  ds_read_b128 v[48:51], v12 offset:12288
  ds_read_b128 v[52:55], v13 offset:12288
  ds_read_b128 v[56:59], v14 offset:12288
  ds_read_b128 v[60:63], v15 offset:12288
  s_waitcnt lgkmcnt(7)
  v_mfma_f32_16x16x32_bf16 v[144:147], v[32:35], v[208:211], 0
  s_waitcnt lgkmcnt(6)
  v_mfma_f32_16x16x32_bf16 v[144:147], v[36:39], v[212:215], v[144:147]
  s_waitcnt lgkmcnt(5)
  v_mfma_f32_16x16x32_bf16 v[144:147], v[40:43], v[216:219], v[144:147]
  s_waitcnt lgkmcnt(4)
  v_mfma_f32_16x16x32_bf16 v[144:147], v[44:47], v[220:223], v[144:147]
  s_nop 3
  v_mfma_f32_16x16x32_bf16 v[148:151], v[32:35], v[224:227], 0
  v_max3_f32 v2, v128, v129, v130
  v_max3_f32 v2, v2, v131, v136
  v_max3_f32 v2, v2, v137, v138
  v_max_f32 v2, v2, v139
  v_max3_f32 v3, v132, v133, v134
  v_max3_f32 v3, v3, v135, v140
  v_max3_f32 v3, v3, v141, v142
  v_mfma_f32_16x16x32_bf16 v[148:151], v[36:39], v[228:231], v[148:151]
  v_max_f32 v3, v3, v143
  v_mov_b32 v4, v2
  v_mov_b32 v5, v3
  s_nop 0
  v_permlane16_swap_b32 v2, v4
  v_permlane16_swap_b32 v3, v5
  v_mfma_f32_16x16x32_bf16 v[148:151], v[40:43], v[232:235], v[148:151]
  v_max_f32 v2, v2, v4
  v_max_f32 v3, v3, v5
  v_mov_b32 v4, v2
  v_mov_b32 v5, v3
  s_nop 0
  v_permlane32_swap_b32 v2, v4
  v_permlane32_swap_b32 v3, v5
  v_mfma_f32_16x16x32_bf16 v[148:151], v[44:47], v[236:239], v[148:151]
  v_max_f32 v2, v2, v4
  v_max_f32 v3, v3, v5
  v_sub_f32 v128, v128, v2
  v_sub_f32 v129, v129, v2
  v_sub_f32 v130, v130, v2
  v_sub_f32 v131, v131, v2
  s_waitcnt lgkmcnt(3)
  v_mfma_f32_16x16x32_bf16 v[152:155], v[48:51], v[208:211], 0
  v_sub_f32 v132, v132, v3
  v_sub_f32 v133, v133, v3
  v_sub_f32 v134, v134, v3
  v_sub_f32 v135, v135, v3
  v_sub_f32 v136, v136, v2
  v_sub_f32 v137, v137, v2
  v_sub_f32 v138, v138, v2
  s_waitcnt lgkmcnt(2)
  v_mfma_f32_16x16x32_bf16 v[152:155], v[52:55], v[212:215], v[152:155]
  v_sub_f32 v139, v139, v2
  v_sub_f32 v140, v140, v3
  v_sub_f32 v141, v141, v3
  v_sub_f32 v142, v142, v3
  v_sub_f32 v143, v143, v3
  v_exp_f32 v24, v128
  s_waitcnt lgkmcnt(1)
  v_mfma_f32_16x16x32_bf16 v[152:155], v[56:59], v[216:219], v[152:155]
  v_exp_f32 v25, v129
  v_exp_f32 v26, v130
  v_exp_f32 v27, v131
  s_waitcnt lgkmcnt(0)
  v_mfma_f32_16x16x32_bf16 v[152:155], v[60:63], v[220:223], v[152:155]
  v_exp_f32 v28, v132
  v_exp_f32 v29, v133
  v_exp_f32 v30, v134
  v_cvt_pk_bf16_f32 v160, v24, v25
  v_mfma_f32_16x16x32_bf16 v[156:159], v[48:51], v[224:227], 0
  v_exp_f32 v31, v135
  v_cvt_pk_bf16_f32 v161, v26, v27
  v_exp_f32 v24, v136
  v_cvt_pk_bf16_f32 v164, v28, v29
  v_mfma_f32_16x16x32_bf16 v[156:159], v[52:55], v[228:231], v[156:159]
  v_exp_f32 v25, v137
  v_cvt_pk_bf16_f32 v165, v30, v31
  v_exp_f32 v26, v138
  v_cvt_pk_bf16_f32 v162, v24, v25
  v_mfma_f32_16x16x32_bf16 v[156:159], v[56:59], v[232:235], v[156:159]
  v_exp_f32 v27, v139
  v_exp_f32 v28, v140
  v_cvt_pk_bf16_f32 v163, v26, v27
  v_exp_f32 v29, v141
  v_mfma_f32_16x16x32_bf16 v[156:159], v[60:63], v[236:239], v[156:159]
  v_exp_f32 v30, v142
  v_cvt_pk_bf16_f32 v166, v28, v29
  v_exp_f32 v31, v143
  s_nop 0
  v_cvt_pk_bf16_f32 v167, v30, v31
  s_nop 1
  v_mfma_f32_16x16x32_bf16 v[176:179], v[192:195], v[160:163], 0
  v_mfma_f32_16x16x32_bf16 v[180:183], v[192:195], v[164:167], 0
  v_sub_f32 v196, 0, v2
  v_sub_f32 v197, 0, v2
  v_sub_f32 v198, 0, v2
  v_sub_f32 v199, 0, v2
  v_sub_f32 v200, 0, v3
  v_sub_f32 v201, 0, v3
  v_sub_f32 v202, 0, v3
  v_sub_f32 v203, 0, v3
  v_sub_f32 v144, v144, v2
  v_sub_f32 v145, v145, v2
  v_sub_f32 v146, v146, v2
  v_sub_f32 v147, v147, v2
  v_sub_f32 v148, v148, v3
  v_sub_f32 v149, v149, v3
  v_sub_f32 v150, v150, v3
  v_sub_f32 v151, v151, v3
  v_sub_f32 v152, v152, v2
  v_sub_f32 v153, v153, v2
  v_sub_f32 v154, v154, v2
  v_sub_f32 v155, v155, v2
  v_sub_f32 v156, v156, v3
  v_sub_f32 v157, v157, v3
  v_sub_f32 v158, v158, v3
  v_sub_f32 v159, v159, v3
  v_exp_f32 v24, v144
  v_exp_f32 v25, v145
  v_exp_f32 v26, v146
  v_exp_f32 v27, v147
  v_exp_f32 v28, v148
  v_exp_f32 v29, v149
  s_mov_b32 s46, 8
  s_waitcnt vmcnt(0)
  s_barrier
  ds_read_b128 v[32:35], v12 offset:16384
  ds_read_b128 v[36:39], v13 offset:16384
  ds_read_b128 v[40:43], v14 offset:16384
  ds_read_b128 v[44:47], v15 offset:16384
  s_branch L_mid
.p2align 6
L_loop:
  s_waitcnt lgkmcnt(0)
  s_barrier
  v_mfma_f32_16x16x32_bf16 v[176:179], v[192:195], v[160:163], v[184:187]
  ds_read_b128 v[32:35], v12 offset:0
  ds_read_b128 v[36:39], v13 offset:0
  v_mfma_f32_16x16x32_bf16 v[180:183], v[192:195], v[164:167], v[188:191]
  v_exp_f32_e64 v24, v144
  v_mfma_f32_16x16x32_bf16 v[96:99], v[48:51], v[168:171], v[96:99]
  ds_read_b128 v[40:43], v14 offset:0
  ds_read_b128 v[44:47], v15 offset:0
  v_mfma_f32_16x16x32_bf16 v[112:115], v[48:51], v[172:175], v[112:115]
  v_exp_f32_e64 v25, v145
  v_mfma_f32_16x16x32_bf16 v[100:103], v[52:55], v[168:171], v[100:103]
  v_exp_f32_e64 v26, v146
  v_mfma_f32_16x16x32_bf16 v[116:119], v[52:55], v[172:175], v[116:119]
  v_exp_f32_e64 v27, v147
  v_mfma_f32_16x16x32_bf16 v[104:107], v[56:59], v[168:171], v[104:107]
  v_add_f32 v4, v176, v180
  v_cmp_nge_f32 vcc, s45, v4
  v_mfma_f32_16x16x32_bf16 v[120:123], v[56:59], v[172:175], v[120:123]
  v_exp_f32_e64 v28, v148
  v_mfma_f32_16x16x32_bf16 v[108:111], v[60:63], v[168:171], v[108:111]
  v_exp_f32_e64 v29, v149
  v_mfma_f32_16x16x32_bf16 v[124:127], v[60:63], v[172:175], v[124:127]
  s_cbranch_vccnz L_fix0
L_ret0:
  s_waitcnt lgkmcnt(0)
  v_mfma_f32_16x16x32_bf16 v[128:131], v[32:35], v[208:211], v[196:199]
  ds_read_b128 v[48:51], v12 offset:4096
  ds_read_b128 v[52:55], v13 offset:4096
  v_mfma_f32_16x16x32_bf16 v[128:131], v[36:39], v[212:215], v[128:131]
  v_exp_f32_e64 v30, v150
  v_mfma_f32_16x16x32_bf16 v[128:131], v[40:43], v[216:219], v[128:131]
  ds_read_b128 v[56:59], v14 offset:4096
  v_cvt_pk_bf16_f32 v168, v24, v25
  v_mfma_f32_16x16x32_bf16 v[128:131], v[44:47], v[220:223], v[128:131]
  ds_read_b128 v[60:63], v15 offset:4096
  v_cvt_pk_bf16_f32 v169, v26, v27
  v_mfma_f32_16x16x32_bf16 v[132:135], v[32:35], v[224:227], v[200:203]
  v_exp_f32_e64 v31, v151
  v_mfma_f32_16x16x32_bf16 v[132:135], v[36:39], v[228:231], v[132:135]
  v_exp_f32_e64 v24, v152
  v_mfma_f32_16x16x32_bf16 v[132:135], v[40:43], v[232:235], v[132:135]
  v_exp_f32 v25, v153
  v_mfma_f32_16x16x32_bf16 v[132:135], v[44:47], v[236:239], v[132:135]
  v_cvt_pk_bf16_f32 v172, v28, v29
  s_waitcnt lgkmcnt(0)
  v_mfma_f32_16x16x32_bf16 v[136:139], v[48:51], v[208:211], v[196:199]
  ds_read_b64_tr_b16 v[32:33], v16 offset:49152
  ds_read_b64_tr_b16 v[34:35], v16 offset:53248
  v_mfma_f32_16x16x32_bf16 v[136:139], v[52:55], v[212:215], v[136:139]
  ds_read_b64_tr_b16 v[36:37], v17 offset:49152
  ds_read_b64_tr_b16 v[38:39], v17 offset:53248
  v_mfma_f32_16x16x32_bf16 v[136:139], v[56:59], v[216:219], v[136:139]
  ds_read_b64_tr_b16 v[40:41], v18 offset:49152
  ds_read_b64_tr_b16 v[42:43], v18 offset:53248
  v_mfma_f32_16x16x32_bf16 v[136:139], v[60:63], v[220:223], v[136:139]
  ds_read_b64_tr_b16 v[44:45], v19 offset:49152
  ds_read_b64_tr_b16 v[46:47], v19 offset:53248
  v_mfma_f32_16x16x32_bf16 v[140:143], v[48:51], v[224:227], v[200:203]
  v_exp_f32_e64 v26, v154
  v_mfma_f32_16x16x32_bf16 v[140:143], v[52:55], v[228:231], v[140:143]
  v_exp_f32_e64 v27, v155
  v_mfma_f32_16x16x32_bf16 v[140:143], v[56:59], v[232:235], v[140:143]
  v_exp_f32 v28, v156
  v_mfma_f32_16x16x32_bf16 v[140:143], v[60:63], v[236:239], v[140:143]
  v_cvt_pk_bf16_f32 v173, v30, v31
  s_waitcnt lgkmcnt(0)
  v_mfma_f32_16x16x32_bf16 v[64:67], v[32:35], v[160:163], v[64:67]
  ds_read_b64_tr_b16 v[48:49], v20 offset:49152
  ds_read_b64_tr_b16 v[50:51], v20 offset:53248
  v_mfma_f32_16x16x32_bf16 v[80:83], v[32:35], v[164:167], v[80:83]
  ds_read_b64_tr_b16 v[52:53], v21 offset:49152
  ds_read_b64_tr_b16 v[54:55], v21 offset:53248
  v_cvt_pk_bf16_f32 v170, v24, v25
  v_mfma_f32_16x16x32_bf16 v[68:71], v[36:39], v[160:163], v[68:71]
  ds_read_b64_tr_b16 v[56:57], v22 offset:49152
  ds_read_b64_tr_b16 v[58:59], v22 offset:53248
  v_mfma_f32_16x16x32_bf16 v[84:87], v[36:39], v[164:167], v[84:87]
  v_exp_f32_e64 v29, v157
  v_mfma_f32_16x16x32_bf16 v[72:75], v[40:43], v[160:163], v[72:75]
  ds_read_b64_tr_b16 v[60:61], v23 offset:49152
  ds_read_b64_tr_b16 v[62:63], v23 offset:53248
  v_cvt_pk_bf16_f32 v171, v26, v27
  v_mfma_f32_16x16x32_bf16 v[88:91], v[40:43], v[164:167], v[88:91]
  v_exp_f32_e64 v30, v158
  v_mfma_f32_16x16x32_bf16 v[76:79], v[44:47], v[160:163], v[76:79]
  v_exp_f32_e64 v31, v159
  v_cvt_pk_bf16_f32 v174, v28, v29
  v_mfma_f32_16x16x32_bf16 v[92:95], v[44:47], v[164:167], v[92:95]
  v_cvt_pk_bf16_f32 v175, v30, v31
  s_waitcnt lgkmcnt(0)
  s_barrier
  v_mfma_f32_16x16x32_bf16 v[184:187], v[192:195], v[168:171], v[176:179]
  ds_read_b128 v[32:35], v12 offset:8192
  ds_read_b128 v[36:39], v13 offset:8192
  v_mfma_f32_16x16x32_bf16 v[188:191], v[192:195], v[172:175], v[180:183]
  v_exp_f32_e64 v24, v128
  v_mfma_f32_16x16x32_bf16 v[96:99], v[48:51], v[160:163], v[96:99]
  ds_read_b128 v[40:43], v14 offset:8192
  ds_read_b128 v[44:47], v15 offset:8192
  v_mfma_f32_16x16x32_bf16 v[112:115], v[48:51], v[164:167], v[112:115]
  v_exp_f32_e64 v25, v129
  v_mfma_f32_16x16x32_bf16 v[100:103], v[52:55], v[160:163], v[100:103]
  v_exp_f32_e64 v26, v130
  v_mfma_f32_16x16x32_bf16 v[116:119], v[52:55], v[164:167], v[116:119]
  v_exp_f32_e64 v27, v131
  v_mfma_f32_16x16x32_bf16 v[104:107], v[56:59], v[160:163], v[104:107]
  v_add_f32 v4, v184, v188
  v_cmp_nge_f32 vcc, s45, v4
  v_mfma_f32_16x16x32_bf16 v[120:123], v[56:59], v[164:167], v[120:123]
  v_exp_f32_e64 v28, v132
  v_mfma_f32_16x16x32_bf16 v[108:111], v[60:63], v[160:163], v[108:111]
  v_exp_f32_e64 v29, v133
  v_mfma_f32_16x16x32_bf16 v[124:127], v[60:63], v[164:167], v[124:127]
  s_cbranch_vccnz L_fix1
L_ret1:
  s_waitcnt lgkmcnt(0)
  v_mfma_f32_16x16x32_bf16 v[144:147], v[32:35], v[208:211], v[196:199]
  ds_read_b128 v[48:51], v12 offset:12288
  ds_read_b128 v[52:55], v13 offset:12288
  v_mfma_f32_16x16x32_bf16 v[144:147], v[36:39], v[212:215], v[144:147]
  v_exp_f32_e64 v30, v134
  v_mfma_f32_16x16x32_bf16 v[144:147], v[40:43], v[216:219], v[144:147]
  ds_read_b128 v[56:59], v14 offset:12288
  v_cvt_pk_bf16_f32 v160, v24, v25
  v_mfma_f32_16x16x32_bf16 v[144:147], v[44:47], v[220:223], v[144:147]
  ds_read_b128 v[60:63], v15 offset:12288
  v_cvt_pk_bf16_f32 v161, v26, v27
  v_mfma_f32_16x16x32_bf16 v[148:151], v[32:35], v[224:227], v[200:203]
  v_exp_f32_e64 v31, v135
  v_mfma_f32_16x16x32_bf16 v[148:151], v[36:39], v[228:231], v[148:151]
  v_exp_f32_e64 v24, v136
  v_mfma_f32_16x16x32_bf16 v[148:151], v[40:43], v[232:235], v[148:151]
  v_exp_f32 v25, v137
  v_mfma_f32_16x16x32_bf16 v[148:151], v[44:47], v[236:239], v[148:151]
  v_cvt_pk_bf16_f32 v164, v28, v29
  s_waitcnt lgkmcnt(0)
  v_mfma_f32_16x16x32_bf16 v[152:155], v[48:51], v[208:211], v[196:199]
  ds_read_b64_tr_b16 v[32:33], v16 offset:57344
  ds_read_b64_tr_b16 v[34:35], v16 offset:61440
  v_mfma_f32_16x16x32_bf16 v[152:155], v[52:55], v[212:215], v[152:155]
  ds_read_b64_tr_b16 v[36:37], v17 offset:57344
  ds_read_b64_tr_b16 v[38:39], v17 offset:61440
  v_mfma_f32_16x16x32_bf16 v[152:155], v[56:59], v[216:219], v[152:155]
  ds_read_b64_tr_b16 v[40:41], v18 offset:57344
  ds_read_b64_tr_b16 v[42:43], v18 offset:61440
  v_mfma_f32_16x16x32_bf16 v[152:155], v[60:63], v[220:223], v[152:155]
  ds_read_b64_tr_b16 v[44:45], v19 offset:57344
  ds_read_b64_tr_b16 v[46:47], v19 offset:61440
  v_mfma_f32_16x16x32_bf16 v[156:159], v[48:51], v[224:227], v[200:203]
  v_exp_f32_e64 v26, v138
  v_mfma_f32_16x16x32_bf16 v[156:159], v[52:55], v[228:231], v[156:159]
  v_exp_f32_e64 v27, v139
  v_mfma_f32_16x16x32_bf16 v[156:159], v[56:59], v[232:235], v[156:159]
  v_exp_f32 v28, v140
  v_mfma_f32_16x16x32_bf16 v[156:159], v[60:63], v[236:239], v[156:159]
  v_cvt_pk_bf16_f32 v165, v30, v31
  s_waitcnt lgkmcnt(0)
  v_mfma_f32_16x16x32_bf16 v[64:67], v[32:35], v[168:171], v[64:67]
  ds_read_b64_tr_b16 v[48:49], v20 offset:57344
  ds_read_b64_tr_b16 v[50:51], v20 offset:61440
  v_mfma_f32_16x16x32_bf16 v[80:83], v[32:35], v[172:175], v[80:83]
  ds_read_b64_tr_b16 v[52:53], v21 offset:57344
  ds_read_b64_tr_b16 v[54:55], v21 offset:61440
  v_cvt_pk_bf16_f32 v162, v24, v25
  v_mfma_f32_16x16x32_bf16 v[68:71], v[36:39], v[168:171], v[68:71]
  ds_read_b64_tr_b16 v[56:57], v22 offset:57344
  ds_read_b64_tr_b16 v[58:59], v22 offset:61440
  v_mfma_f32_16x16x32_bf16 v[84:87], v[36:39], v[172:175], v[84:87]
  v_exp_f32_e64 v29, v141
  v_mfma_f32_16x16x32_bf16 v[72:75], v[40:43], v[168:171], v[72:75]
  ds_read_b64_tr_b16 v[60:61], v23 offset:57344
  ds_read_b64_tr_b16 v[62:63], v23 offset:61440
  v_cvt_pk_bf16_f32 v163, v26, v27
  v_mfma_f32_16x16x32_bf16 v[88:91], v[40:43], v[172:175], v[88:91]
  v_exp_f32_e64 v30, v142
  v_mfma_f32_16x16x32_bf16 v[76:79], v[44:47], v[168:171], v[76:79]
  v_exp_f32_e64 v31, v143
  v_cvt_pk_bf16_f32 v166, v28, v29
  v_mfma_f32_16x16x32_bf16 v[92:95], v[44:47], v[172:175], v[92:95]
  v_cvt_pk_bf16_f32 v167, v30, v31
  s_waitcnt lgkmcnt(0)
  s_barrier
  v_mfma_f32_16x16x32_bf16 v[176:179], v[192:195], v[160:163], v[184:187]
  ds_read_b128 v[32:35], v12 offset:16384
  ds_read_b128 v[36:39], v13 offset:16384
  v_mfma_f32_16x16x32_bf16 v[180:183], v[192:195], v[164:167], v[188:191]
  v_exp_f32_e64 v24, v144
  v_mfma_f32_16x16x32_bf16 v[96:99], v[48:51], v[168:171], v[96:99]
  ds_read_b128 v[40:43], v14 offset:16384
  ds_read_b128 v[44:47], v15 offset:16384
  v_mfma_f32_16x16x32_bf16 v[112:115], v[48:51], v[172:175], v[112:115]
  v_exp_f32_e64 v25, v145
  v_mfma_f32_16x16x32_bf16 v[100:103], v[52:55], v[168:171], v[100:103]
  v_exp_f32_e64 v26, v146
  v_mfma_f32_16x16x32_bf16 v[116:119], v[52:55], v[172:175], v[116:119]
  v_exp_f32_e64 v27, v147
  v_mfma_f32_16x16x32_bf16 v[104:107], v[56:59], v[168:171], v[104:107]
  v_add_f32 v4, v176, v180
  v_cmp_nge_f32 vcc, s45, v4
  v_mfma_f32_16x16x32_bf16 v[120:123], v[56:59], v[172:175], v[120:123]
  v_exp_f32_e64 v28, v148
  v_mfma_f32_16x16x32_bf16 v[108:111], v[60:63], v[168:171], v[108:111]
  v_exp_f32_e64 v29, v149
  v_mfma_f32_16x16x32_bf16 v[124:127], v[60:63], v[172:175], v[124:127]
  s_cbranch_vccnz L_fix2
L_ret2:
L_mid:
  s_waitcnt lgkmcnt(0)
  v_mfma_f32_16x16x32_bf16 v[128:131], v[32:35], v[208:211], v[196:199]
  ds_read_b128 v[48:51], v12 offset:20480
  ds_read_b128 v[52:55], v13 offset:20480
  v_mfma_f32_16x16x32_bf16 v[128:131], v[36:39], v[212:215], v[128:131]
  v_exp_f32_e64 v30, v150
  v_mfma_f32_16x16x32_bf16 v[128:131], v[40:43], v[216:219], v[128:131]
  ds_read_b128 v[56:59], v14 offset:20480
  v_cvt_pk_bf16_f32 v168, v24, v25
  v_mfma_f32_16x16x32_bf16 v[128:131], v[44:47], v[220:223], v[128:131]
  ds_read_b128 v[60:63], v15 offset:20480
  v_cvt_pk_bf16_f32 v169, v26, v27
  v_mfma_f32_16x16x32_bf16 v[132:135], v[32:35], v[224:227], v[200:203]
  v_exp_f32_e64 v31, v151
  v_mfma_f32_16x16x32_bf16 v[132:135], v[36:39], v[228:231], v[132:135]
  v_exp_f32_e64 v24, v152
  v_mfma_f32_16x16x32_bf16 v[132:135], v[40:43], v[232:235], v[132:135]
  v_exp_f32 v25, v153
  v_mfma_f32_16x16x32_bf16 v[132:135], v[44:47], v[236:239], v[132:135]
  v_cvt_pk_bf16_f32 v172, v28, v29
  s_waitcnt lgkmcnt(0)
  v_mfma_f32_16x16x32_bf16 v[136:139], v[48:51], v[208:211], v[196:199]
  ds_read_b64_tr_b16 v[32:33], v16 offset:0
  ds_read_b64_tr_b16 v[34:35], v16 offset:4096
  v_mfma_f32_16x16x32_bf16 v[136:139], v[52:55], v[212:215], v[136:139]
  ds_read_b64_tr_b16 v[36:37], v17 offset:0
  ds_read_b64_tr_b16 v[38:39], v17 offset:4096
  v_mfma_f32_16x16x32_bf16 v[136:139], v[56:59], v[216:219], v[136:139]
  ds_read_b64_tr_b16 v[40:41], v18 offset:0
  ds_read_b64_tr_b16 v[42:43], v18 offset:4096
  v_mfma_f32_16x16x32_bf16 v[136:139], v[60:63], v[220:223], v[136:139]
  ds_read_b64_tr_b16 v[44:45], v19 offset:0
  ds_read_b64_tr_b16 v[46:47], v19 offset:4096
  v_mfma_f32_16x16x32_bf16 v[140:143], v[48:51], v[224:227], v[200:203]
  v_exp_f32_e64 v26, v154
  v_mfma_f32_16x16x32_bf16 v[140:143], v[52:55], v[228:231], v[140:143]
  v_exp_f32_e64 v27, v155
  v_mfma_f32_16x16x32_bf16 v[140:143], v[56:59], v[232:235], v[140:143]
  v_exp_f32 v28, v156
  v_mfma_f32_16x16x32_bf16 v[140:143], v[60:63], v[236:239], v[140:143]
  v_cvt_pk_bf16_f32 v173, v30, v31
  s_waitcnt lgkmcnt(0)
  v_mfma_f32_16x16x32_bf16 v[64:67], v[32:35], v[160:163], v[64:67]
  ds_read_b64_tr_b16 v[48:49], v20 offset:0
  ds_read_b64_tr_b16 v[50:51], v20 offset:4096
  v_mfma_f32_16x16x32_bf16 v[80:83], v[32:35], v[164:167], v[80:83]
  ds_read_b64_tr_b16 v[52:53], v21 offset:0
  ds_read_b64_tr_b16 v[54:55], v21 offset:4096
  v_cvt_pk_bf16_f32 v170, v24, v25
  v_mfma_f32_16x16x32_bf16 v[68:71], v[36:39], v[160:163], v[68:71]
  ds_read_b64_tr_b16 v[56:57], v22 offset:0
  ds_read_b64_tr_b16 v[58:59], v22 offset:4096
  v_mfma_f32_16x16x32_bf16 v[84:87], v[36:39], v[164:167], v[84:87]
  v_exp_f32_e64 v29, v157
  v_mfma_f32_16x16x32_bf16 v[72:75], v[40:43], v[160:163], v[72:75]
  ds_read_b64_tr_b16 v[60:61], v23 offset:0
  ds_read_b64_tr_b16 v[62:63], v23 offset:4096
  v_cvt_pk_bf16_f32 v171, v26, v27
  v_mfma_f32_16x16x32_bf16 v[88:91], v[40:43], v[164:167], v[88:91]
  v_exp_f32_e64 v30, v158
  v_mfma_f32_16x16x32_bf16 v[76:79], v[44:47], v[160:163], v[76:79]
  v_exp_f32_e64 v31, v159
  v_cvt_pk_bf16_f32 v174, v28, v29
  v_mfma_f32_16x16x32_bf16 v[92:95], v[44:47], v[164:167], v[92:95]
  v_cvt_pk_bf16_f32 v175, v30, v31
  s_waitcnt lgkmcnt(0)
  s_barrier
  v_mfma_f32_16x16x32_bf16 v[184:187], v[192:195], v[168:171], v[176:179]
  ds_read_b128 v[32:35], v12 offset:24576
  ds_read_b128 v[36:39], v13 offset:24576
  v_mfma_f32_16x16x32_bf16 v[188:191], v[192:195], v[172:175], v[180:183]
  v_exp_f32_e64 v24, v128
  v_mfma_f32_16x16x32_bf16 v[96:99], v[48:51], v[160:163], v[96:99]
  ds_read_b128 v[40:43], v14 offset:24576
  ds_read_b128 v[44:47], v15 offset:24576
  v_mfma_f32_16x16x32_bf16 v[112:115], v[48:51], v[164:167], v[112:115]
  v_exp_f32_e64 v25, v129
  v_mfma_f32_16x16x32_bf16 v[100:103], v[52:55], v[160:163], v[100:103]
  v_exp_f32_e64 v26, v130
  v_mfma_f32_16x16x32_bf16 v[116:119], v[52:55], v[164:167], v[116:119]
  v_exp_f32_e64 v27, v131
  v_mfma_f32_16x16x32_bf16 v[104:107], v[56:59], v[160:163], v[104:107]
  v_add_f32 v4, v184, v188
  v_cmp_nge_f32 vcc, s45, v4
  v_mfma_f32_16x16x32_bf16 v[120:123], v[56:59], v[164:167], v[120:123]
  v_exp_f32_e64 v28, v132
  v_mfma_f32_16x16x32_bf16 v[108:111], v[60:63], v[160:163], v[108:111]
  v_exp_f32_e64 v29, v133
  v_mfma_f32_16x16x32_bf16 v[124:127], v[60:63], v[164:167], v[124:127]
  s_cbranch_vccnz L_fix3
L_ret3:
  s_waitcnt lgkmcnt(0)
  v_mfma_f32_16x16x32_bf16 v[144:147], v[32:35], v[208:211], v[196:199]
  ds_read_b128 v[48:51], v12 offset:28672
  ds_read_b128 v[52:55], v13 offset:28672
  v_mfma_f32_16x16x32_bf16 v[144:147], v[36:39], v[212:215], v[144:147]
  v_exp_f32_e64 v30, v134
  v_mfma_f32_16x16x32_bf16 v[144:147], v[40:43], v[216:219], v[144:147]
  ds_read_b128 v[56:59], v14 offset:28672
  v_cvt_pk_bf16_f32 v160, v24, v25
  v_mfma_f32_16x16x32_bf16 v[144:147], v[44:47], v[220:223], v[144:147]
  ds_read_b128 v[60:63], v15 offset:28672
  v_cvt_pk_bf16_f32 v161, v26, v27
  v_mfma_f32_16x16x32_bf16 v[148:151], v[32:35], v[224:227], v[200:203]
  v_exp_f32_e64 v31, v135
  v_mfma_f32_16x16x32_bf16 v[148:151], v[36:39], v[228:231], v[148:151]
  v_exp_f32_e64 v24, v136
  v_mfma_f32_16x16x32_bf16 v[148:151], v[40:43], v[232:235], v[148:151]
  v_exp_f32 v25, v137
  v_mfma_f32_16x16x32_bf16 v[148:151], v[44:47], v[236:239], v[148:151]
  v_cvt_pk_bf16_f32 v164, v28, v29
  s_waitcnt lgkmcnt(0)
  v_mfma_f32_16x16x32_bf16 v[152:155], v[48:51], v[208:211], v[196:199]
  ds_read_b64_tr_b16 v[32:33], v16 offset:8192
  ds_read_b64_tr_b16 v[34:35], v16 offset:12288
  v_mfma_f32_16x16x32_bf16 v[152:155], v[52:55], v[212:215], v[152:155]
  ds_read_b64_tr_b16 v[36:37], v17 offset:8192
  ds_read_b64_tr_b16 v[38:39], v17 offset:12288
  v_mfma_f32_16x16x32_bf16 v[152:155], v[56:59], v[216:219], v[152:155]
  ds_read_b64_tr_b16 v[40:41], v18 offset:8192
  ds_read_b64_tr_b16 v[42:43], v18 offset:12288
  v_mfma_f32_16x16x32_bf16 v[152:155], v[60:63], v[220:223], v[152:155]
  ds_read_b64_tr_b16 v[44:45], v19 offset:8192
  ds_read_b64_tr_b16 v[46:47], v19 offset:12288
  v_mfma_f32_16x16x32_bf16 v[156:159], v[48:51], v[224:227], v[200:203]
  v_exp_f32_e64 v26, v138
  v_mfma_f32_16x16x32_bf16 v[156:159], v[52:55], v[228:231], v[156:159]
  v_exp_f32_e64 v27, v139
  v_mfma_f32_16x16x32_bf16 v[156:159], v[56:59], v[232:235], v[156:159]
  v_exp_f32 v28, v140
  v_mfma_f32_16x16x32_bf16 v[156:159], v[60:63], v[236:239], v[156:159]
  v_cvt_pk_bf16_f32 v165, v30, v31
  s_waitcnt lgkmcnt(0)
  v_mfma_f32_16x16x32_bf16 v[64:67], v[32:35], v[168:171], v[64:67]
  ds_read_b64_tr_b16 v[48:49], v20 offset:8192
  ds_read_b64_tr_b16 v[50:51], v20 offset:12288
  v_mfma_f32_16x16x32_bf16 v[80:83], v[32:35], v[172:175], v[80:83]
  ds_read_b64_tr_b16 v[52:53], v21 offset:8192
  ds_read_b64_tr_b16 v[54:55], v21 offset:12288
  v_cvt_pk_bf16_f32 v162, v24, v25
  v_mfma_f32_16x16x32_bf16 v[68:71], v[36:39], v[168:171], v[68:71]
  ds_read_b64_tr_b16 v[56:57], v22 offset:8192
  ds_read_b64_tr_b16 v[58:59], v22 offset:12288
  v_mfma_f32_16x16x32_bf16 v[84:87], v[36:39], v[172:175], v[84:87]
  v_exp_f32_e64 v29, v141
  v_mfma_f32_16x16x32_bf16 v[72:75], v[40:43], v[168:171], v[72:75]
  ds_read_b64_tr_b16 v[60:61], v23 offset:8192
  ds_read_b64_tr_b16 v[62:63], v23 offset:12288
  v_cvt_pk_bf16_f32 v163, v26, v27
  v_mfma_f32_16x16x32_bf16 v[88:91], v[40:43], v[172:175], v[88:91]
  v_exp_f32_e64 v30, v142
  v_mfma_f32_16x16x32_bf16 v[76:79], v[44:47], v[168:171], v[76:79]
  v_exp_f32_e64 v31, v143
  v_cvt_pk_bf16_f32 v166, v28, v29
  v_mfma_f32_16x16x32_bf16 v[92:95], v[44:47], v[172:175], v[92:95]
  v_cvt_pk_bf16_f32 v167, v30, v31
  s_waitcnt lgkmcnt(0)
  s_barrier
  v_mfma_f32_16x16x32_bf16 v[176:179], v[192:195], v[160:163], v[184:187]
  ds_read_b128 v[32:35], v12 offset:32768
  ds_read_b128 v[36:39], v13 offset:32768
  v_mfma_f32_16x16x32_bf16 v[180:183], v[192:195], v[164:167], v[188:191]
  v_exp_f32_e64 v24, v144
  v_mfma_f32_16x16x32_bf16 v[96:99], v[48:51], v[168:171], v[96:99]
  ds_read_b128 v[40:43], v14 offset:32768
  ds_read_b128 v[44:47], v15 offset:32768
  v_mfma_f32_16x16x32_bf16 v[112:115], v[48:51], v[172:175], v[112:115]
  v_exp_f32_e64 v25, v145
  v_mfma_f32_16x16x32_bf16 v[100:103], v[52:55], v[168:171], v[100:103]
  v_exp_f32_e64 v26, v146
  v_mfma_f32_16x16x32_bf16 v[116:119], v[52:55], v[172:175], v[116:119]
  v_exp_f32_e64 v27, v147
  v_mfma_f32_16x16x32_bf16 v[104:107], v[56:59], v[168:171], v[104:107]
  v_add_f32 v4, v176, v180
  v_cmp_nge_f32 vcc, s45, v4
  v_mfma_f32_16x16x32_bf16 v[120:123], v[56:59], v[172:175], v[120:123]
  v_exp_f32_e64 v28, v148
  v_mfma_f32_16x16x32_bf16 v[108:111], v[60:63], v[168:171], v[108:111]
  v_exp_f32_e64 v29, v149
  v_mfma_f32_16x16x32_bf16 v[124:127], v[60:63], v[172:175], v[124:127]
  s_cbranch_vccnz L_fix4
L_ret4:
  s_waitcnt lgkmcnt(0)
  v_mfma_f32_16x16x32_bf16 v[128:131], v[32:35], v[208:211], v[196:199]
  ds_read_b128 v[48:51], v12 offset:36864
  ds_read_b128 v[52:55], v13 offset:36864
  v_mfma_f32_16x16x32_bf16 v[128:131], v[36:39], v[212:215], v[128:131]
  v_exp_f32_e64 v30, v150
  v_mfma_f32_16x16x32_bf16 v[128:131], v[40:43], v[216:219], v[128:131]
  ds_read_b128 v[56:59], v14 offset:36864
  v_cvt_pk_bf16_f32 v168, v24, v25
  v_mfma_f32_16x16x32_bf16 v[128:131], v[44:47], v[220:223], v[128:131]
  ds_read_b128 v[60:63], v15 offset:36864
  v_cvt_pk_bf16_f32 v169, v26, v27
  v_mfma_f32_16x16x32_bf16 v[132:135], v[32:35], v[224:227], v[200:203]
  v_exp_f32_e64 v31, v151
  v_mfma_f32_16x16x32_bf16 v[132:135], v[36:39], v[228:231], v[132:135]
  v_exp_f32_e64 v24, v152
  v_mfma_f32_16x16x32_bf16 v[132:135], v[40:43], v[232:235], v[132:135]
  v_exp_f32 v25, v153
  v_mfma_f32_16x16x32_bf16 v[132:135], v[44:47], v[236:239], v[132:135]
  v_cvt_pk_bf16_f32 v172, v28, v29
  s_waitcnt lgkmcnt(0)
  v_mfma_f32_16x16x32_bf16 v[136:139], v[48:51], v[208:211], v[196:199]
  ds_read_b64_tr_b16 v[32:33], v16 offset:16384
  ds_read_b64_tr_b16 v[34:35], v16 offset:20480
  v_mfma_f32_16x16x32_bf16 v[136:139], v[52:55], v[212:215], v[136:139]
  ds_read_b64_tr_b16 v[36:37], v17 offset:16384
  ds_read_b64_tr_b16 v[38:39], v17 offset:20480
  v_mfma_f32_16x16x32_bf16 v[136:139], v[56:59], v[216:219], v[136:139]
  ds_read_b64_tr_b16 v[40:41], v18 offset:16384
  ds_read_b64_tr_b16 v[42:43], v18 offset:20480
  v_mfma_f32_16x16x32_bf16 v[136:139], v[60:63], v[220:223], v[136:139]
  ds_read_b64_tr_b16 v[44:45], v19 offset:16384
  ds_read_b64_tr_b16 v[46:47], v19 offset:20480
  v_mfma_f32_16x16x32_bf16 v[140:143], v[48:51], v[224:227], v[200:203]
  v_exp_f32_e64 v26, v154
  v_mfma_f32_16x16x32_bf16 v[140:143], v[52:55], v[228:231], v[140:143]
  v_exp_f32_e64 v27, v155
  v_mfma_f32_16x16x32_bf16 v[140:143], v[56:59], v[232:235], v[140:143]
  v_exp_f32 v28, v156
  v_mfma_f32_16x16x32_bf16 v[140:143], v[60:63], v[236:239], v[140:143]
  v_cvt_pk_bf16_f32 v173, v30, v31
  s_waitcnt lgkmcnt(0)
  v_mfma_f32_16x16x32_bf16 v[64:67], v[32:35], v[160:163], v[64:67]
  ds_read_b64_tr_b16 v[48:49], v20 offset:16384
  ds_read_b64_tr_b16 v[50:51], v20 offset:20480
  v_mfma_f32_16x16x32_bf16 v[80:83], v[32:35], v[164:167], v[80:83]
  ds_read_b64_tr_b16 v[52:53], v21 offset:16384
  ds_read_b64_tr_b16 v[54:55], v21 offset:20480
  v_cvt_pk_bf16_f32 v170, v24, v25
  v_mfma_f32_16x16x32_bf16 v[68:71], v[36:39], v[160:163], v[68:71]
  ds_read_b64_tr_b16 v[56:57], v22 offset:16384
  ds_read_b64_tr_b16 v[58:59], v22 offset:20480
  v_mfma_f32_16x16x32_bf16 v[84:87], v[36:39], v[164:167], v[84:87]
  v_exp_f32_e64 v29, v157
  v_mfma_f32_16x16x32_bf16 v[72:75], v[40:43], v[160:163], v[72:75]
  ds_read_b64_tr_b16 v[60:61], v23 offset:16384
  ds_read_b64_tr_b16 v[62:63], v23 offset:20480
  v_cvt_pk_bf16_f32 v171, v26, v27
  v_mfma_f32_16x16x32_bf16 v[88:91], v[40:43], v[164:167], v[88:91]
  v_exp_f32_e64 v30, v158
  v_mfma_f32_16x16x32_bf16 v[76:79], v[44:47], v[160:163], v[76:79]
  v_exp_f32_e64 v31, v159
  v_cvt_pk_bf16_f32 v174, v28, v29
  v_mfma_f32_16x16x32_bf16 v[92:95], v[44:47], v[164:167], v[92:95]
  v_cvt_pk_bf16_f32 v175, v30, v31
  s_waitcnt lgkmcnt(0)
  s_barrier
  v_mfma_f32_16x16x32_bf16 v[184:187], v[192:195], v[168:171], v[176:179]
  ds_read_b128 v[32:35], v12 offset:40960
  ds_read_b128 v[36:39], v13 offset:40960
  v_mfma_f32_16x16x32_bf16 v[188:191], v[192:195], v[172:175], v[180:183]
  v_exp_f32_e64 v24, v128
  v_mfma_f32_16x16x32_bf16 v[96:99], v[48:51], v[160:163], v[96:99]
  ds_read_b128 v[40:43], v14 offset:40960
  ds_read_b128 v[44:47], v15 offset:40960
  v_mfma_f32_16x16x32_bf16 v[112:115], v[48:51], v[164:167], v[112:115]
  v_exp_f32_e64 v25, v129
  v_mfma_f32_16x16x32_bf16 v[100:103], v[52:55], v[160:163], v[100:103]
  v_exp_f32_e64 v26, v130
  v_mfma_f32_16x16x32_bf16 v[116:119], v[52:55], v[164:167], v[116:119]
  v_exp_f32_e64 v27, v131
  v_mfma_f32_16x16x32_bf16 v[104:107], v[56:59], v[160:163], v[104:107]
  v_add_f32 v4, v184, v188
  v_cmp_nge_f32 vcc, s45, v4
  v_mfma_f32_16x16x32_bf16 v[120:123], v[56:59], v[164:167], v[120:123]
  v_exp_f32_e64 v28, v132
  v_mfma_f32_16x16x32_bf16 v[108:111], v[60:63], v[160:163], v[108:111]
  v_exp_f32_e64 v29, v133
  v_mfma_f32_16x16x32_bf16 v[124:127], v[60:63], v[164:167], v[124:127]
  s_cbranch_vccnz L_fix5
L_ret5:
  s_waitcnt lgkmcnt(0)
  v_mfma_f32_16x16x32_bf16 v[144:147], v[32:35], v[208:211], v[196:199]
  ds_read_b128 v[48:51], v12 offset:45056
  ds_read_b128 v[52:55], v13 offset:45056
  v_mfma_f32_16x16x32_bf16 v[144:147], v[36:39], v[212:215], v[144:147]
  v_exp_f32_e64 v30, v134
  v_mfma_f32_16x16x32_bf16 v[144:147], v[40:43], v[216:219], v[144:147]
  ds_read_b128 v[56:59], v14 offset:45056
  v_cvt_pk_bf16_f32 v160, v24, v25
  v_mfma_f32_16x16x32_bf16 v[144:147], v[44:47], v[220:223], v[144:147]
  ds_read_b128 v[60:63], v15 offset:45056
  v_cvt_pk_bf16_f32 v161, v26, v27
  v_mfma_f32_16x16x32_bf16 v[148:151], v[32:35], v[224:227], v[200:203]
  v_exp_f32_e64 v31, v135
  v_mfma_f32_16x16x32_bf16 v[148:151], v[36:39], v[228:231], v[148:151]
  v_exp_f32_e64 v24, v136
  v_mfma_f32_16x16x32_bf16 v[148:151], v[40:43], v[232:235], v[148:151]
  v_exp_f32 v25, v137
  v_mfma_f32_16x16x32_bf16 v[148:151], v[44:47], v[236:239], v[148:151]
  v_cvt_pk_bf16_f32 v164, v28, v29
  s_waitcnt lgkmcnt(0)
  v_mfma_f32_16x16x32_bf16 v[152:155], v[48:51], v[208:211], v[196:199]
  ds_read_b64_tr_b16 v[32:33], v16 offset:24576
  ds_read_b64_tr_b16 v[34:35], v16 offset:28672
  v_mfma_f32_16x16x32_bf16 v[152:155], v[52:55], v[212:215], v[152:155]
  ds_read_b64_tr_b16 v[36:37], v17 offset:24576
  ds_read_b64_tr_b16 v[38:39], v17 offset:28672
  v_mfma_f32_16x16x32_bf16 v[152:155], v[56:59], v[216:219], v[152:155]
  ds_read_b64_tr_b16 v[40:41], v18 offset:24576
  ds_read_b64_tr_b16 v[42:43], v18 offset:28672
  v_mfma_f32_16x16x32_bf16 v[152:155], v[60:63], v[220:223], v[152:155]
  ds_read_b64_tr_b16 v[44:45], v19 offset:24576
  ds_read_b64_tr_b16 v[46:47], v19 offset:28672
  v_mfma_f32_16x16x32_bf16 v[156:159], v[48:51], v[224:227], v[200:203]
  v_exp_f32_e64 v26, v138
  v_mfma_f32_16x16x32_bf16 v[156:159], v[52:55], v[228:231], v[156:159]
  v_exp_f32_e64 v27, v139
  v_mfma_f32_16x16x32_bf16 v[156:159], v[56:59], v[232:235], v[156:159]
  v_exp_f32 v28, v140
  v_mfma_f32_16x16x32_bf16 v[156:159], v[60:63], v[236:239], v[156:159]
  v_cvt_pk_bf16_f32 v165, v30, v31
  s_waitcnt lgkmcnt(0)
  v_mfma_f32_16x16x32_bf16 v[64:67], v[32:35], v[168:171], v[64:67]
  ds_read_b64_tr_b16 v[48:49], v20 offset:24576
  ds_read_b64_tr_b16 v[50:51], v20 offset:28672
  v_mfma_f32_16x16x32_bf16 v[80:83], v[32:35], v[172:175], v[80:83]
  ds_read_b64_tr_b16 v[52:53], v21 offset:24576
  ds_read_b64_tr_b16 v[54:55], v21 offset:28672
  v_cvt_pk_bf16_f32 v162, v24, v25
  v_mfma_f32_16x16x32_bf16 v[68:71], v[36:39], v[168:171], v[68:71]
  ds_read_b64_tr_b16 v[56:57], v22 offset:24576
  ds_read_b64_tr_b16 v[58:59], v22 offset:28672
  v_mfma_f32_16x16x32_bf16 v[84:87], v[36:39], v[172:175], v[84:87]
  v_exp_f32_e64 v29, v141
  v_mfma_f32_16x16x32_bf16 v[72:75], v[40:43], v[168:171], v[72:75]
  ds_read_b64_tr_b16 v[60:61], v23 offset:24576
  ds_read_b64_tr_b16 v[62:63], v23 offset:28672
  v_cvt_pk_bf16_f32 v163, v26, v27
  v_mfma_f32_16x16x32_bf16 v[88:91], v[40:43], v[172:175], v[88:91]
  v_exp_f32_e64 v30, v142
  v_mfma_f32_16x16x32_bf16 v[76:79], v[44:47], v[168:171], v[76:79]
  v_exp_f32_e64 v31, v143
  v_cvt_pk_bf16_f32 v166, v28, v29
  v_mfma_f32_16x16x32_bf16 v[92:95], v[44:47], v[172:175], v[92:95]
  v_cvt_pk_bf16_f32 v167, v30, v31
  s_waitcnt lgkmcnt(0)
  s_barrier
  v_mfma_f32_16x16x32_bf16 v[176:179], v[192:195], v[160:163], v[184:187]
  ds_read_b128 v[32:35], v12 offset:49152
  ds_read_b128 v[36:39], v13 offset:49152
  v_mfma_f32_16x16x32_bf16 v[180:183], v[192:195], v[164:167], v[188:191]
  v_exp_f32_e64 v24, v144
  v_mfma_f32_16x16x32_bf16 v[96:99], v[48:51], v[168:171], v[96:99]
  ds_read_b128 v[40:43], v14 offset:49152
  ds_read_b128 v[44:47], v15 offset:49152
  v_mfma_f32_16x16x32_bf16 v[112:115], v[48:51], v[172:175], v[112:115]
  v_exp_f32_e64 v25, v145
  v_mfma_f32_16x16x32_bf16 v[100:103], v[52:55], v[168:171], v[100:103]
  v_exp_f32_e64 v26, v146
  v_mfma_f32_16x16x32_bf16 v[116:119], v[52:55], v[172:175], v[116:119]
  v_exp_f32_e64 v27, v147
  v_mfma_f32_16x16x32_bf16 v[104:107], v[56:59], v[168:171], v[104:107]
  v_add_f32 v4, v176, v180
  v_cmp_nge_f32 vcc, s45, v4
  v_mfma_f32_16x16x32_bf16 v[120:123], v[56:59], v[172:175], v[120:123]
  v_exp_f32_e64 v28, v148
  v_mfma_f32_16x16x32_bf16 v[108:111], v[60:63], v[168:171], v[108:111]
  v_exp_f32_e64 v29, v149
  v_mfma_f32_16x16x32_bf16 v[124:127], v[60:63], v[172:175], v[124:127]
  s_cbranch_vccnz L_fix6
L_ret6:
  s_waitcnt lgkmcnt(0)
  v_mfma_f32_16x16x32_bf16 v[128:131], v[32:35], v[208:211], v[196:199]
  ds_read_b128 v[48:51], v12 offset:53248
  ds_read_b128 v[52:55], v13 offset:53248
  v_mfma_f32_16x16x32_bf16 v[128:131], v[36:39], v[212:215], v[128:131]
  v_exp_f32_e64 v30, v150
  v_mfma_f32_16x16x32_bf16 v[128:131], v[40:43], v[216:219], v[128:131]
  ds_read_b128 v[56:59], v14 offset:53248
  v_cvt_pk_bf16_f32 v168, v24, v25
  v_mfma_f32_16x16x32_bf16 v[128:131], v[44:47], v[220:223], v[128:131]
  ds_read_b128 v[60:63], v15 offset:53248
  v_cvt_pk_bf16_f32 v169, v26, v27
  v_mfma_f32_16x16x32_bf16 v[132:135], v[32:35], v[224:227], v[200:203]
  v_exp_f32_e64 v31, v151
  v_mfma_f32_16x16x32_bf16 v[132:135], v[36:39], v[228:231], v[132:135]
  v_exp_f32_e64 v24, v152
  v_mfma_f32_16x16x32_bf16 v[132:135], v[40:43], v[232:235], v[132:135]
  v_exp_f32 v25, v153
  v_mfma_f32_16x16x32_bf16 v[132:135], v[44:47], v[236:239], v[132:135]
  v_cvt_pk_bf16_f32 v172, v28, v29
  s_waitcnt lgkmcnt(0)
  v_mfma_f32_16x16x32_bf16 v[136:139], v[48:51], v[208:211], v[196:199]
  ds_read_b64_tr_b16 v[32:33], v16 offset:32768
  ds_read_b64_tr_b16 v[34:35], v16 offset:36864
  v_mfma_f32_16x16x32_bf16 v[136:139], v[52:55], v[212:215], v[136:139]
  ds_read_b64_tr_b16 v[36:37], v17 offset:32768
  ds_read_b64_tr_b16 v[38:39], v17 offset:36864
  v_mfma_f32_16x16x32_bf16 v[136:139], v[56:59], v[216:219], v[136:139]
  ds_read_b64_tr_b16 v[40:41], v18 offset:32768
  ds_read_b64_tr_b16 v[42:43], v18 offset:36864
  v_mfma_f32_16x16x32_bf16 v[136:139], v[60:63], v[220:223], v[136:139]
  ds_read_b64_tr_b16 v[44:45], v19 offset:32768
  ds_read_b64_tr_b16 v[46:47], v19 offset:36864
  v_mfma_f32_16x16x32_bf16 v[140:143], v[48:51], v[224:227], v[200:203]
  v_exp_f32_e64 v26, v154
  v_mfma_f32_16x16x32_bf16 v[140:143], v[52:55], v[228:231], v[140:143]
  v_exp_f32_e64 v27, v155
  v_mfma_f32_16x16x32_bf16 v[140:143], v[56:59], v[232:235], v[140:143]
  v_exp_f32 v28, v156
  v_mfma_f32_16x16x32_bf16 v[140:143], v[60:63], v[236:239], v[140:143]
  v_cvt_pk_bf16_f32 v173, v30, v31
  s_waitcnt lgkmcnt(0)
  v_mfma_f32_16x16x32_bf16 v[64:67], v[32:35], v[160:163], v[64:67]
  ds_read_b64_tr_b16 v[48:49], v20 offset:32768
  ds_read_b64_tr_b16 v[50:51], v20 offset:36864
  v_mfma_f32_16x16x32_bf16 v[80:83], v[32:35], v[164:167], v[80:83]
  ds_read_b64_tr_b16 v[52:53], v21 offset:32768
  ds_read_b64_tr_b16 v[54:55], v21 offset:36864
  v_cvt_pk_bf16_f32 v170, v24, v25
  v_mfma_f32_16x16x32_bf16 v[68:71], v[36:39], v[160:163], v[68:71]
  ds_read_b64_tr_b16 v[56:57], v22 offset:32768
  ds_read_b64_tr_b16 v[58:59], v22 offset:36864
  v_mfma_f32_16x16x32_bf16 v[84:87], v[36:39], v[164:167], v[84:87]
  v_exp_f32_e64 v29, v157
  v_mfma_f32_16x16x32_bf16 v[72:75], v[40:43], v[160:163], v[72:75]
  ds_read_b64_tr_b16 v[60:61], v23 offset:32768
  ds_read_b64_tr_b16 v[62:63], v23 offset:36864
  v_cvt_pk_bf16_f32 v171, v26, v27
  v_mfma_f32_16x16x32_bf16 v[88:91], v[40:43], v[164:167], v[88:91]
  v_exp_f32_e64 v30, v158
  v_mfma_f32_16x16x32_bf16 v[76:79], v[44:47], v[160:163], v[76:79]
  v_exp_f32_e64 v31, v159
  v_cvt_pk_bf16_f32 v174, v28, v29
  v_mfma_f32_16x16x32_bf16 v[92:95], v[44:47], v[164:167], v[92:95]
  v_cvt_pk_bf16_f32 v175, v30, v31
  s_waitcnt lgkmcnt(0)
  s_barrier
  v_mfma_f32_16x16x32_bf16 v[184:187], v[192:195], v[168:171], v[176:179]
  ds_read_b128 v[32:35], v12 offset:57344
  ds_read_b128 v[36:39], v13 offset:57344
  v_mfma_f32_16x16x32_bf16 v[188:191], v[192:195], v[172:175], v[180:183]
  v_exp_f32_e64 v24, v128
  v_mfma_f32_16x16x32_bf16 v[96:99], v[48:51], v[160:163], v[96:99]
  ds_read_b128 v[40:43], v14 offset:57344
  ds_read_b128 v[44:47], v15 offset:57344
  v_mfma_f32_16x16x32_bf16 v[112:115], v[48:51], v[164:167], v[112:115]
  v_exp_f32_e64 v25, v129
  v_mfma_f32_16x16x32_bf16 v[100:103], v[52:55], v[160:163], v[100:103]
  v_exp_f32_e64 v26, v130
  v_mfma_f32_16x16x32_bf16 v[116:119], v[52:55], v[164:167], v[116:119]
  v_exp_f32_e64 v27, v131
  v_mfma_f32_16x16x32_bf16 v[104:107], v[56:59], v[160:163], v[104:107]
  v_add_f32 v4, v184, v188
  v_cmp_nge_f32 vcc, s45, v4
  v_mfma_f32_16x16x32_bf16 v[120:123], v[56:59], v[164:167], v[120:123]
  v_exp_f32_e64 v28, v132
  v_mfma_f32_16x16x32_bf16 v[108:111], v[60:63], v[160:163], v[108:111]
  v_exp_f32_e64 v29, v133
  v_mfma_f32_16x16x32_bf16 v[124:127], v[60:63], v[164:167], v[124:127]
  s_cbranch_vccnz L_fix7
L_ret7:
  s_waitcnt lgkmcnt(0)
  v_mfma_f32_16x16x32_bf16 v[144:147], v[32:35], v[208:211], v[196:199]
  ds_read_b128 v[48:51], v12 offset:61440
  ds_read_b128 v[52:55], v13 offset:61440
  v_mfma_f32_16x16x32_bf16 v[144:147], v[36:39], v[212:215], v[144:147]
  v_exp_f32_e64 v30, v134
  v_mfma_f32_16x16x32_bf16 v[144:147], v[40:43], v[216:219], v[144:147]
  ds_read_b128 v[56:59], v14 offset:61440
  v_cvt_pk_bf16_f32 v160, v24, v25
  v_mfma_f32_16x16x32_bf16 v[144:147], v[44:47], v[220:223], v[144:147]
  ds_read_b128 v[60:63], v15 offset:61440
  v_cvt_pk_bf16_f32 v161, v26, v27
  v_mfma_f32_16x16x32_bf16 v[148:151], v[32:35], v[224:227], v[200:203]
  v_exp_f32_e64 v31, v135
  v_mfma_f32_16x16x32_bf16 v[148:151], v[36:39], v[228:231], v[148:151]
  v_exp_f32_e64 v24, v136
  v_mfma_f32_16x16x32_bf16 v[148:151], v[40:43], v[232:235], v[148:151]
  v_exp_f32 v25, v137
  v_mfma_f32_16x16x32_bf16 v[148:151], v[44:47], v[236:239], v[148:151]
  v_cvt_pk_bf16_f32 v164, v28, v29
  s_waitcnt lgkmcnt(0)
  v_mfma_f32_16x16x32_bf16 v[152:155], v[48:51], v[208:211], v[196:199]
  ds_read_b64_tr_b16 v[32:33], v16 offset:40960
  ds_read_b64_tr_b16 v[34:35], v16 offset:45056
  v_mfma_f32_16x16x32_bf16 v[152:155], v[52:55], v[212:215], v[152:155]
  ds_read_b64_tr_b16 v[36:37], v17 offset:40960
  ds_read_b64_tr_b16 v[38:39], v17 offset:45056
  v_mfma_f32_16x16x32_bf16 v[152:155], v[56:59], v[216:219], v[152:155]
  ds_read_b64_tr_b16 v[40:41], v18 offset:40960
  ds_read_b64_tr_b16 v[42:43], v18 offset:45056
  v_mfma_f32_16x16x32_bf16 v[152:155], v[60:63], v[220:223], v[152:155]
  ds_read_b64_tr_b16 v[44:45], v19 offset:40960
  ds_read_b64_tr_b16 v[46:47], v19 offset:45056
  v_mfma_f32_16x16x32_bf16 v[156:159], v[48:51], v[224:227], v[200:203]
  v_exp_f32_e64 v26, v138
  v_mfma_f32_16x16x32_bf16 v[156:159], v[52:55], v[228:231], v[156:159]
  v_exp_f32_e64 v27, v139
  v_mfma_f32_16x16x32_bf16 v[156:159], v[56:59], v[232:235], v[156:159]
  v_exp_f32 v28, v140
  v_mfma_f32_16x16x32_bf16 v[156:159], v[60:63], v[236:239], v[156:159]
  v_cvt_pk_bf16_f32 v165, v30, v31
  s_waitcnt lgkmcnt(0)
  v_mfma_f32_16x16x32_bf16 v[64:67], v[32:35], v[168:171], v[64:67]
  ds_read_b64_tr_b16 v[48:49], v20 offset:40960
  ds_read_b64_tr_b16 v[50:51], v20 offset:45056
  v_mfma_f32_16x16x32_bf16 v[80:83], v[32:35], v[172:175], v[80:83]
  ds_read_b64_tr_b16 v[52:53], v21 offset:40960
  ds_read_b64_tr_b16 v[54:55], v21 offset:45056
  v_cvt_pk_bf16_f32 v162, v24, v25
  v_mfma_f32_16x16x32_bf16 v[68:71], v[36:39], v[168:171], v[68:71]
  ds_read_b64_tr_b16 v[56:57], v22 offset:40960
  ds_read_b64_tr_b16 v[58:59], v22 offset:45056
  v_mfma_f32_16x16x32_bf16 v[84:87], v[36:39], v[172:175], v[84:87]
  v_exp_f32_e64 v29, v141
  v_mfma_f32_16x16x32_bf16 v[72:75], v[40:43], v[168:171], v[72:75]
  ds_read_b64_tr_b16 v[60:61], v23 offset:40960
  ds_read_b64_tr_b16 v[62:63], v23 offset:45056
  v_cvt_pk_bf16_f32 v163, v26, v27
  v_mfma_f32_16x16x32_bf16 v[88:91], v[40:43], v[172:175], v[88:91]
  v_exp_f32_e64 v30, v142
  v_mfma_f32_16x16x32_bf16 v[76:79], v[44:47], v[168:171], v[76:79]
  v_exp_f32 v31, v143
  v_cvt_pk_bf16_f32 v166, v28, v29
  s_sub_u32 s46, s46, 1
  s_cmp_lg_u32 s46, 0
  v_mfma_f32_16x16x32_bf16 v[92:95], v[44:47], v[172:175], v[92:95]
  v_cvt_pk_bf16_f32 v167, v30, v31
  s_cbranch_scc1 L_loop
  v_mov_b32 v6, 131072
  ds_read_b32 v7, v6
  s_waitcnt lgkmcnt(0)
  v_readfirstlane_b32 s43, v7
  s_waitcnt lgkmcnt(0)
  s_barrier
  v_mfma_f32_16x16x32_bf16 v[176:179], v[192:195], v[160:163], v[184:187]
  ds_read_b64_tr_b16 v[32:33], v16 offset:49152
  ds_read_b64_tr_b16 v[34:35], v16 offset:53248
  ds_read_b64_tr_b16 v[36:37], v17 offset:49152
  ds_read_b64_tr_b16 v[38:39], v17 offset:53248
  v_mfma_f32_16x16x32_bf16 v[180:183], v[192:195], v[164:167], v[188:191]
  v_exp_f32 v24, v144
  v_mfma_f32_16x16x32_bf16 v[96:99], v[48:51], v[168:171], v[96:99]
  ds_read_b64_tr_b16 v[40:41], v18 offset:49152
  ds_read_b64_tr_b16 v[42:43], v18 offset:53248
  ds_read_b64_tr_b16 v[44:45], v19 offset:49152
  ds_read_b64_tr_b16 v[46:47], v19 offset:53248
  v_mfma_f32_16x16x32_bf16 v[112:115], v[48:51], v[172:175], v[112:115]
  v_exp_f32 v25, v145
  v_mfma_f32_16x16x32_bf16 v[100:103], v[52:55], v[168:171], v[100:103]
  v_exp_f32 v26, v146
  v_mfma_f32_16x16x32_bf16 v[116:119], v[52:55], v[172:175], v[116:119]
  v_exp_f32 v27, v147
  v_mfma_f32_16x16x32_bf16 v[104:107], v[56:59], v[168:171], v[104:107]
  v_add_f32 v4, v176, v180
  v_cmp_nge_f32 vcc, s45, v4
  v_mfma_f32_16x16x32_bf16 v[120:123], v[56:59], v[172:175], v[120:123]
  v_exp_f32 v28, v148
  v_mfma_f32_16x16x32_bf16 v[108:111], v[60:63], v[168:171], v[108:111]
  v_exp_f32 v29, v149
  v_mfma_f32_16x16x32_bf16 v[124:127], v[60:63], v[172:175], v[124:127]
  s_cbranch_vccnz L_fix8
L_ret8:
  s_waitcnt lgkmcnt(6)
  v_mfma_f32_16x16x32_bf16 v[64:67], v[32:35], v[160:163], v[64:67]
  ds_read_b64_tr_b16 v[48:49], v20 offset:49152
  ds_read_b64_tr_b16 v[50:51], v20 offset:53248
  v_exp_f32 v30, v150
  v_cvt_pk_bf16_f32 v168, v24, v25
  v_mfma_f32_16x16x32_bf16 v[80:83], v[32:35], v[164:167], v[80:83]
  ds_read_b64_tr_b16 v[52:53], v21 offset:49152
  ds_read_b64_tr_b16 v[54:55], v21 offset:53248
  v_exp_f32 v31, v151
  v_cvt_pk_bf16_f32 v169, v26, v27
  v_exp_f32 v24, v152
  s_waitcnt lgkmcnt(8)
  v_mfma_f32_16x16x32_bf16 v[68:71], v[36:39], v[160:163], v[68:71]
  ds_read_b64_tr_b16 v[56:57], v22 offset:49152
  ds_read_b64_tr_b16 v[58:59], v22 offset:53248
  v_cvt_pk_bf16_f32 v172, v28, v29
  v_exp_f32 v25, v153
  v_mfma_f32_16x16x32_bf16 v[84:87], v[36:39], v[164:167], v[84:87]
  ds_read_b64_tr_b16 v[60:61], v23 offset:49152
  ds_read_b64_tr_b16 v[62:63], v23 offset:53248
  v_cvt_pk_bf16_f32 v173, v30, v31
  v_exp_f32 v26, v154
  v_cvt_pk_bf16_f32 v170, v24, v25
  s_waitcnt lgkmcnt(10)
  v_mfma_f32_16x16x32_bf16 v[72:75], v[40:43], v[160:163], v[72:75]
  v_exp_f32 v27, v155
  v_exp_f32 v28, v156
  v_mfma_f32_16x16x32_bf16 v[88:91], v[40:43], v[164:167], v[88:91]
  v_cvt_pk_bf16_f32 v171, v26, v27
  v_exp_f32 v29, v157
  s_waitcnt lgkmcnt(8)
  v_mfma_f32_16x16x32_bf16 v[76:79], v[44:47], v[160:163], v[76:79]
  v_exp_f32 v30, v158
  v_cvt_pk_bf16_f32 v174, v28, v29
  v_mfma_f32_16x16x32_bf16 v[92:95], v[44:47], v[164:167], v[92:95]
  v_exp_f32 v31, v159
  s_nop 0
  v_cvt_pk_bf16_f32 v175, v30, v31
  s_nop 1
  v_mfma_f32_16x16x32_bf16 v[184:187], v[192:195], v[168:171], v[176:179]
  v_mfma_f32_16x16x32_bf16 v[188:191], v[192:195], v[172:175], v[180:183]
  s_waitcnt lgkmcnt(6)
  v_mfma_f32_16x16x32_bf16 v[96:99], v[48:51], v[160:163], v[96:99]
  v_mfma_f32_16x16x32_bf16 v[112:115], v[48:51], v[164:167], v[112:115]
  s_waitcnt lgkmcnt(4)
  v_mfma_f32_16x16x32_bf16 v[100:103], v[52:55], v[160:163], v[100:103]
  v_mfma_f32_16x16x32_bf16 v[116:119], v[52:55], v[164:167], v[116:119]
  s_waitcnt lgkmcnt(2)
  v_mfma_f32_16x16x32_bf16 v[104:107], v[56:59], v[160:163], v[104:107]
  s_nop 3
  v_add_f32 v4, v184, v188
  v_cmp_nge_f32 vcc, s45, v4
  v_mfma_f32_16x16x32_bf16 v[120:123], v[56:59], v[164:167], v[120:123]
  s_waitcnt lgkmcnt(0)
  v_mfma_f32_16x16x32_bf16 v[108:111], v[60:63], v[160:163], v[108:111]
  v_mfma_f32_16x16x32_bf16 v[124:127], v[60:63], v[164:167], v[124:127]
  s_cbranch_vccnz L_fix9
L_ret9:
  v_mov_b32 v24, v2
  v_mov_b32 v25, v3
  v_mov_b32 v26, v184
  v_mov_b32 v27, v188
  s_cmp_eq_u32 s43, 4
  s_cbranch_scc0 L_far
  s_mov_b64 exec, 0xffff
  buffer_store_dwordx4 v[24:27], v8, s[32:35], s58 offen
  s_mov_b64 exec, -1
  s_barrier
  ds_read_b64_tr_b16 v[32:33], v20 offset:57344
  ds_read_b64_tr_b16 v[34:35], v20 offset:61440
  ds_read_b64_tr_b16 v[36:37], v21 offset:57344
  ds_read_b64_tr_b16 v[38:39], v21 offset:61440
  ds_read_b64_tr_b16 v[40:41], v22 offset:57344
  ds_read_b64_tr_b16 v[42:43], v22 offset:61440
  ds_read_b64_tr_b16 v[44:45], v23 offset:57344
  ds_read_b64_tr_b16 v[46:47], v23 offset:61440
  ds_read_b64_tr_b16 v[48:49], v16 offset:57344
  ds_read_b64_tr_b16 v[50:51], v16 offset:61440
  ds_read_b64_tr_b16 v[52:53], v17 offset:57344
  ds_read_b64_tr_b16 v[54:55], v17 offset:61440
  ds_read_b64_tr_b16 v[56:57], v18 offset:57344
  ds_read_b64_tr_b16 v[58:59], v18 offset:61440
  s_waitcnt lgkmcnt(12)
  v_mfma_f32_16x16x32_bf16 v[96:99], v[32:35], v[168:171], v[96:99]
  s_waitcnt lgkmcnt(10)
  v_mfma_f32_16x16x32_bf16 v[100:103], v[36:39], v[168:171], v[100:103]
  ds_read_b64_tr_b16 v[60:61], v19 offset:57344
  ds_read_b64_tr_b16 v[62:63], v19 offset:61440
  s_waitcnt lgkmcnt(10)
  v_mfma_f32_16x16x32_bf16 v[104:107], v[40:43], v[168:171], v[104:107]
  s_waitcnt lgkmcnt(8)
  v_mfma_f32_16x16x32_bf16 v[108:111], v[44:47], v[168:171], v[108:111]
  v_mfma_f32_16x16x32_bf16 v[112:115], v[32:35], v[172:175], v[112:115]
  v_mfma_f32_16x16x32_bf16 v[116:119], v[36:39], v[172:175], v[116:119]
  v_mfma_f32_16x16x32_bf16 v[120:123], v[40:43], v[172:175], v[120:123]
  v_mfma_f32_16x16x32_bf16 v[124:127], v[44:47], v[172:175], v[124:127]
  s_waitcnt lgkmcnt(6)
  v_mfma_f32_16x16x32_bf16 v[80:83], v[48:51], v[172:175], v[80:83]
  v_cvt_pk_bf16_f32 v136, v96, v97
  v_cvt_pk_bf16_f32 v137, v98, v99
  s_waitcnt lgkmcnt(4)
  v_mfma_f32_16x16x32_bf16 v[84:87], v[52:55], v[172:175], v[84:87]
  v_cvt_pk_bf16_f32 v138, v100, v101
  v_cvt_pk_bf16_f32 v139, v102, v103
  buffer_store_dwordx4 v[136:139], v8, s[32:35], s55 offen offset:0
  s_waitcnt lgkmcnt(2)
  v_mfma_f32_16x16x32_bf16 v[88:91], v[56:59], v[172:175], v[88:91]
  v_cvt_pk_bf16_f32 v140, v104, v105
  v_cvt_pk_bf16_f32 v141, v106, v107
  s_waitcnt lgkmcnt(0)
  v_mfma_f32_16x16x32_bf16 v[92:95], v[60:63], v[172:175], v[92:95]
  v_cvt_pk_bf16_f32 v142, v108, v109
  v_cvt_pk_bf16_f32 v143, v110, v111
  buffer_store_dwordx4 v[140:143], v8, s[32:35], s55 offen offset:1024
  v_mfma_f32_16x16x32_bf16 v[64:67], v[48:51], v[168:171], v[64:67]
  v_cvt_pk_bf16_f32 v144, v112, v113
  v_cvt_pk_bf16_f32 v145, v114, v115
  v_cvt_pk_bf16_f32 v146, v116, v117
  v_cvt_pk_bf16_f32 v147, v118, v119
  buffer_store_dwordx4 v[144:147], v8, s[32:35], s56 offen offset:0
  v_mfma_f32_16x16x32_bf16 v[68:71], v[52:55], v[168:171], v[68:71]
  v_cvt_pk_bf16_f32 v148, v120, v121
  v_cvt_pk_bf16_f32 v149, v122, v123
  v_cvt_pk_bf16_f32 v150, v124, v125
  v_cvt_pk_bf16_f32 v151, v126, v127
  buffer_store_dwordx4 v[148:151], v8, s[32:35], s56 offen offset:1024
  v_mfma_f32_16x16x32_bf16 v[72:75], v[56:59], v[168:171], v[72:75]
  v_cvt_pk_bf16_f32 v128, v80, v81
  v_cvt_pk_bf16_f32 v129, v82, v83
  v_cvt_pk_bf16_f32 v130, v84, v85
  v_cvt_pk_bf16_f32 v131, v86, v87
  buffer_store_dwordx4 v[128:131], v205, s[28:31], 0 offen offset:0
  v_mfma_f32_16x16x32_bf16 v[76:79], v[60:63], v[168:171], v[76:79]
  v_cvt_pk_bf16_f32 v132, v88, v89
  v_cvt_pk_bf16_f32 v133, v90, v91
  v_cvt_pk_bf16_f32 v134, v92, v93
  v_cvt_pk_bf16_f32 v135, v94, v95
  buffer_store_dwordx4 v[132:135], v205, s[28:31], 0 offen offset:2048
  v_mov_b32 v5, 1
  s_mov_b64 exec, 1
  s_waitcnt vmcnt(0)
  buffer_store_dword v5, off, s[32:35], s63
  s_mov_b64 exec, 15
L_poll:
  buffer_load_dword v5, v9, s[32:35], s62 offen sc1
  s_waitcnt vmcnt(0)
  v_cmp_ne_u32 vcc, 1, v5
  s_cbranch_vccnz L_poll
L_got:
  s_mov_b64 exec, -1
  buffer_load_dwordx4 v[32:35], v206, s[32:35], s59 offen sc1
  buffer_load_dwordx4 v[36:39], v206, s[32:35], s60 offen sc1
  buffer_load_dwordx4 v[40:43], v206, s[32:35], s61 offen sc1
  buffer_load_dwordx4 v[128:131], v204, s[28:31], 0 offen offset:0 sc1
  buffer_load_dwordx4 v[132:135], v204, s[28:31], 0 offen offset:2048 sc1
  buffer_load_dwordx4 v[136:139], v8, s[32:35], s57 offen offset:0 sc1
  buffer_load_dwordx4 v[140:143], v8, s[32:35], s57 offen offset:1024 sc1
  buffer_load_dwordx4 v[144:147], v8, s[32:35], s57 offen offset:2048 sc1
  buffer_load_dwordx4 v[148:151], v8, s[32:35], s57 offen offset:3072 sc1
  s_waitcnt vmcnt(6)
  v_max3_f32 v4, v24, v33, v36
  v_max_f32 v4, v4, v41
  v_sub_f32 v48, v24, v4
  v_sub_f32 v49, v33, v4
  v_sub_f32 v50, v36, v4
  v_sub_f32 v51, v41, v4
  v_exp_f32 v48, v48
  v_exp_f32 v49, v49
  v_exp_f32 v50, v50
  v_exp_f32 v51, v51
  s_waitcnt vmcnt(5)
  v_lshlrev_b32 v80, 16, v128
  v_mul_f32 v4, v48, v26
  v_and_b32 v81, 0xffff0000, v128
  v_lshlrev_b32 v82, 16, v129
  v_fmac_f32 v4, v49, v35
  v_and_b32 v83, 0xffff0000, v129
  v_lshlrev_b32 v84, 16, v130
  v_fmac_f32 v4, v50, v38
  v_and_b32 v85, 0xffff0000, v130
  v_lshlrev_b32 v86, 16, v131
  v_fmac_f32 v4, v51, v43
  v_and_b32 v87, 0xffff0000, v131
  s_waitcnt vmcnt(4)
  v_rcp_f32 v4, v4
  v_lshlrev_b32 v88, 16, v132
  v_and_b32 v89, 0xffff0000, v132
  v_pk_mul_f32 v[48:49], v[48:49], v[4:5] op_sel_hi:[1,0]
  v_lshlrev_b32 v90, 16, v133
  v_and_b32 v91, 0xffff0000, v133
  v_pk_mul_f32 v[50:51], v[50:51], v[4:5] op_sel_hi:[1,0]
  v_lshlrev_b32 v92, 16, v134
  v_and_b32 v93, 0xffff0000, v134
  v_lshlrev_b32 v94, 16, v135
  v_and_b32 v95, 0xffff0000, v135
  s_waitcnt vmcnt(3)
  v_lshlrev_b32 v96, 16, v136
  v_and_b32 v97, 0xffff0000, v136
  v_lshlrev_b32 v98, 16, v137
  v_and_b32 v99, 0xffff0000, v137
  v_lshlrev_b32 v100, 16, v138
  v_and_b32 v101, 0xffff0000, v138
  v_lshlrev_b32 v102, 16, v139
  v_and_b32 v103, 0xffff0000, v139
  s_waitcnt vmcnt(2)
  v_lshlrev_b32 v104, 16, v140
  v_and_b32 v105, 0xffff0000, v140
  v_lshlrev_b32 v106, 16, v141
  v_and_b32 v107, 0xffff0000, v141
  v_lshlrev_b32 v108, 16, v142
  v_and_b32 v109, 0xffff0000, v142
  v_lshlrev_b32 v110, 16, v143
  v_and_b32 v111, 0xffff0000, v143
  s_waitcnt vmcnt(1)
  v_lshlrev_b32 v112, 16, v144
  v_and_b32 v113, 0xffff0000, v144
  v_lshlrev_b32 v114, 16, v145
  v_and_b32 v115, 0xffff0000, v145
  v_lshlrev_b32 v116, 16, v146
  v_and_b32 v117, 0xffff0000, v146
  v_lshlrev_b32 v118, 16, v147
  v_and_b32 v119, 0xffff0000, v147
  s_waitcnt vmcnt(0)
  v_lshlrev_b32 v120, 16, v148
  v_and_b32 v121, 0xffff0000, v148
  v_lshlrev_b32 v122, 16, v149
  v_and_b32 v123, 0xffff0000, v149
  v_lshlrev_b32 v124, 16, v150
  v_and_b32 v125, 0xffff0000, v150
  v_lshlrev_b32 v126, 16, v151
  v_and_b32 v127, 0xffff0000, v151
  v_pk_mul_f32 v[64:65], v[64:65], v[48:49] op_sel:[0,0] op_sel_hi:[1,0]
  v_pk_mul_f32 v[66:67], v[66:67], v[48:49] op_sel:[0,0] op_sel_hi:[1,0]
  v_pk_mul_f32 v[68:69], v[68:69], v[48:49] op_sel:[0,0] op_sel_hi:[1,0]
  v_pk_mul_f32 v[70:71], v[70:71], v[48:49] op_sel:[0,0] op_sel_hi:[1,0]
  v_pk_mul_f32 v[72:73], v[72:73], v[48:49] op_sel:[0,0] op_sel_hi:[1,0]
  v_pk_mul_f32 v[74:75], v[74:75], v[48:49] op_sel:[0,0] op_sel_hi:[1,0]
  v_pk_mul_f32 v[76:77], v[76:77], v[48:49] op_sel:[0,0] op_sel_hi:[1,0]
  v_pk_mul_f32 v[78:79], v[78:79], v[48:49] op_sel:[0,0] op_sel_hi:[1,0]
  v_pk_fma_f32 v[64:65], v[80:81], v[48:49], v[64:65] op_sel:[0,1,0] op_sel_hi:[1,1,1]
  v_pk_fma_f32 v[66:67], v[82:83], v[48:49], v[66:67] op_sel:[0,1,0] op_sel_hi:[1,1,1]
  v_pk_fma_f32 v[68:69], v[84:85], v[48:49], v[68:69] op_sel:[0,1,0] op_sel_hi:[1,1,1]
  v_pk_fma_f32 v[70:71], v[86:87], v[48:49], v[70:71] op_sel:[0,1,0] op_sel_hi:[1,1,1]
  v_pk_fma_f32 v[72:73], v[88:89], v[48:49], v[72:73] op_sel:[0,1,0] op_sel_hi:[1,1,1]
  v_pk_fma_f32 v[74:75], v[90:91], v[48:49], v[74:75] op_sel:[0,1,0] op_sel_hi:[1,1,1]
  v_pk_fma_f32 v[76:77], v[92:93], v[48:49], v[76:77] op_sel:[0,1,0] op_sel_hi:[1,1,1]
  v_pk_fma_f32 v[78:79], v[94:95], v[48:49], v[78:79] op_sel:[0,1,0] op_sel_hi:[1,1,1]
  v_pk_fma_f32 v[64:65], v[96:97], v[50:51], v[64:65] op_sel:[0,0,0] op_sel_hi:[1,0,1]
  v_pk_fma_f32 v[66:67], v[98:99], v[50:51], v[66:67] op_sel:[0,0,0] op_sel_hi:[1,0,1]
  v_pk_fma_f32 v[68:69], v[100:101], v[50:51], v[68:69] op_sel:[0,0,0] op_sel_hi:[1,0,1]
  v_pk_fma_f32 v[70:71], v[102:103], v[50:51], v[70:71] op_sel:[0,0,0] op_sel_hi:[1,0,1]
  v_pk_fma_f32 v[72:73], v[104:105], v[50:51], v[72:73] op_sel:[0,0,0] op_sel_hi:[1,0,1]
  v_pk_fma_f32 v[74:75], v[106:107], v[50:51], v[74:75] op_sel:[0,0,0] op_sel_hi:[1,0,1]
  v_pk_fma_f32 v[76:77], v[108:109], v[50:51], v[76:77] op_sel:[0,0,0] op_sel_hi:[1,0,1]
  v_pk_fma_f32 v[78:79], v[110:111], v[50:51], v[78:79] op_sel:[0,0,0] op_sel_hi:[1,0,1]
  v_pk_fma_f32 v[64:65], v[112:113], v[50:51], v[64:65] op_sel:[0,1,0] op_sel_hi:[1,1,1]
  v_pk_fma_f32 v[66:67], v[114:115], v[50:51], v[66:67] op_sel:[0,1,0] op_sel_hi:[1,1,1]
  v_pk_fma_f32 v[68:69], v[116:117], v[50:51], v[68:69] op_sel:[0,1,0] op_sel_hi:[1,1,1]
  v_pk_fma_f32 v[70:71], v[118:119], v[50:51], v[70:71] op_sel:[0,1,0] op_sel_hi:[1,1,1]
  v_pk_fma_f32 v[72:73], v[120:121], v[50:51], v[72:73] op_sel:[0,1,0] op_sel_hi:[1,1,1]
  v_pk_fma_f32 v[74:75], v[122:123], v[50:51], v[74:75] op_sel:[0,1,0] op_sel_hi:[1,1,1]
  v_pk_fma_f32 v[76:77], v[124:125], v[50:51], v[76:77] op_sel:[0,1,0] op_sel_hi:[1,1,1]
  v_pk_fma_f32 v[78:79], v[126:127], v[50:51], v[78:79] op_sel:[0,1,0] op_sel_hi:[1,1,1]
  v_cvt_pk_bf16_f32 v32, v64, v65
  v_cvt_pk_bf16_f32 v33, v66, v67
  v_cvt_pk_bf16_f32 v34, v68, v69
  v_cvt_pk_bf16_f32 v35, v70, v71
  v_cvt_pk_bf16_f32 v36, v72, v73
  v_cvt_pk_bf16_f32 v37, v74, v75
  v_cvt_pk_bf16_f32 v38, v76, v77
  v_cvt_pk_bf16_f32 v39, v78, v79
  v_permlane16_swap_b32 v32, v34
  v_permlane16_swap_b32 v33, v35
  buffer_store_dwordx4 v[32:35], v10, s[28:31], 0 offen
  v_permlane16_swap_b32 v36, v38
  v_permlane16_swap_b32 v37, v39
  buffer_store_dwordx4 v[36:39], v10, s[28:31], 0 offen offset:64
  s_endpgm
L_far:
  s_mov_b64 exec, 0xffff
  buffer_store_dwordx4 v[24:27], v8, s[32:35], s58 offen sc1
  s_mov_b64 exec, -1
  s_barrier
  ds_read_b64_tr_b16 v[32:33], v20 offset:57344
  ds_read_b64_tr_b16 v[34:35], v20 offset:61440
  ds_read_b64_tr_b16 v[36:37], v21 offset:57344
  ds_read_b64_tr_b16 v[38:39], v21 offset:61440
  ds_read_b64_tr_b16 v[40:41], v22 offset:57344
  ds_read_b64_tr_b16 v[42:43], v22 offset:61440
  ds_read_b64_tr_b16 v[44:45], v23 offset:57344
  ds_read_b64_tr_b16 v[46:47], v23 offset:61440
  ds_read_b64_tr_b16 v[48:49], v16 offset:57344
  ds_read_b64_tr_b16 v[50:51], v16 offset:61440
  ds_read_b64_tr_b16 v[52:53], v17 offset:57344
  ds_read_b64_tr_b16 v[54:55], v17 offset:61440
  ds_read_b64_tr_b16 v[56:57], v18 offset:57344
  ds_read_b64_tr_b16 v[58:59], v18 offset:61440
  s_waitcnt lgkmcnt(12)
  v_mfma_f32_16x16x32_bf16 v[96:99], v[32:35], v[168:171], v[96:99]
  s_waitcnt lgkmcnt(10)
  v_mfma_f32_16x16x32_bf16 v[100:103], v[36:39], v[168:171], v[100:103]
  ds_read_b64_tr_b16 v[60:61], v19 offset:57344
  ds_read_b64_tr_b16 v[62:63], v19 offset:61440
  s_waitcnt lgkmcnt(10)
  v_mfma_f32_16x16x32_bf16 v[104:107], v[40:43], v[168:171], v[104:107]
  s_waitcnt lgkmcnt(8)
  v_mfma_f32_16x16x32_bf16 v[108:111], v[44:47], v[168:171], v[108:111]
  v_mfma_f32_16x16x32_bf16 v[112:115], v[32:35], v[172:175], v[112:115]
  v_mfma_f32_16x16x32_bf16 v[116:119], v[36:39], v[172:175], v[116:119]
  v_mfma_f32_16x16x32_bf16 v[120:123], v[40:43], v[172:175], v[120:123]
  v_mfma_f32_16x16x32_bf16 v[124:127], v[44:47], v[172:175], v[124:127]
  s_waitcnt lgkmcnt(6)
  v_mfma_f32_16x16x32_bf16 v[80:83], v[48:51], v[172:175], v[80:83]
  v_cvt_pk_bf16_f32 v136, v96, v97
  v_cvt_pk_bf16_f32 v137, v98, v99
  s_waitcnt lgkmcnt(4)
  v_mfma_f32_16x16x32_bf16 v[84:87], v[52:55], v[172:175], v[84:87]
  v_cvt_pk_bf16_f32 v138, v100, v101
  v_cvt_pk_bf16_f32 v139, v102, v103
  buffer_store_dwordx4 v[136:139], v8, s[32:35], s55 offen offset:0 sc1
  s_waitcnt lgkmcnt(2)
  v_mfma_f32_16x16x32_bf16 v[88:91], v[56:59], v[172:175], v[88:91]
  v_cvt_pk_bf16_f32 v140, v104, v105
  v_cvt_pk_bf16_f32 v141, v106, v107
  s_waitcnt lgkmcnt(0)
  v_mfma_f32_16x16x32_bf16 v[92:95], v[60:63], v[172:175], v[92:95]
  v_cvt_pk_bf16_f32 v142, v108, v109
  v_cvt_pk_bf16_f32 v143, v110, v111
  buffer_store_dwordx4 v[140:143], v8, s[32:35], s55 offen offset:1024 sc1
  v_mfma_f32_16x16x32_bf16 v[64:67], v[48:51], v[168:171], v[64:67]
  v_cvt_pk_bf16_f32 v144, v112, v113
  v_cvt_pk_bf16_f32 v145, v114, v115
  v_cvt_pk_bf16_f32 v146, v116, v117
  v_cvt_pk_bf16_f32 v147, v118, v119
  buffer_store_dwordx4 v[144:147], v8, s[32:35], s56 offen offset:0 sc1
  v_mfma_f32_16x16x32_bf16 v[68:71], v[52:55], v[168:171], v[68:71]
  v_cvt_pk_bf16_f32 v148, v120, v121
  v_cvt_pk_bf16_f32 v149, v122, v123
  v_cvt_pk_bf16_f32 v150, v124, v125
  v_cvt_pk_bf16_f32 v151, v126, v127
  buffer_store_dwordx4 v[148:151], v8, s[32:35], s56 offen offset:1024 sc1
  v_mfma_f32_16x16x32_bf16 v[72:75], v[56:59], v[168:171], v[72:75]
  v_cvt_pk_bf16_f32 v128, v80, v81
  v_cvt_pk_bf16_f32 v129, v82, v83
  v_cvt_pk_bf16_f32 v130, v84, v85
  v_cvt_pk_bf16_f32 v131, v86, v87
  buffer_store_dwordx4 v[128:131], v205, s[28:31], 0 offen offset:0 sc1
  v_mfma_f32_16x16x32_bf16 v[76:79], v[60:63], v[168:171], v[76:79]
  v_cvt_pk_bf16_f32 v132, v88, v89
  v_cvt_pk_bf16_f32 v133, v90, v91
  v_cvt_pk_bf16_f32 v134, v92, v93
  v_cvt_pk_bf16_f32 v135, v94, v95
  buffer_store_dwordx4 v[132:135], v205, s[28:31], 0 offen offset:2048 sc1
  v_mov_b32 v5, 1
  s_mov_b64 exec, 1
  s_waitcnt vmcnt(0)
  buffer_store_dword v5, off, s[32:35], s63 sc1
  s_mov_b64 exec, 15
L_fpoll:
  buffer_load_dword v5, v9, s[32:35], s62 offen sc1
  s_waitcnt vmcnt(0)
  v_cmp_ne_u32 vcc, 1, v5
  s_cbranch_vccnz L_fpoll
  buffer_inv sc1
  s_waitcnt vmcnt(0)
  s_branch L_got
L_fix0:
  s_call_b64 s[66:67], L_fixfn0
  s_branch L_ret0
L_fix1:
  s_call_b64 s[66:67], L_fixfn1
  s_branch L_ret1
L_fix2:
  s_call_b64 s[66:67], L_fixfn0
  s_branch L_ret2
L_fix3:
  s_call_b64 s[66:67], L_fixfn1
  s_branch L_ret3
L_fix4:
  s_call_b64 s[66:67], L_fixfn0
  s_branch L_ret4
L_fix5:
  s_call_b64 s[66:67], L_fixfn1
  s_branch L_ret5
L_fix6:
  s_call_b64 s[66:67], L_fixfn0
  s_branch L_ret6
L_fix7:
  s_call_b64 s[66:67], L_fixfn1
  s_branch L_ret7
L_fix8:
  s_call_b64 s[66:67], L_fixfn0
  s_branch L_ret8
L_fix9:
  s_call_b64 s[66:67], L_fixfn1
  s_branch L_ret9
L_fixfn0:
  s_nop 7
  v_max3_f32 v4, v128, v129, v130
  v_max3_f32 v4, v4, v131, v136
  v_max3_f32 v4, v4, v137, v138
  v_max_f32 v4, v4, v139
  v_max3_f32 v5, v132, v133, v134
  v_max3_f32 v5, v5, v135, v140
  v_max3_f32 v5, v5, v141, v142
  v_max_f32 v5, v5, v143
  v_mov_b32 v6, v4
  s_nop 1
  v_permlane16_swap_b32 v4, v6
  v_max_f32 v4, v4, v6
  v_mov_b32 v6, v4
  s_nop 1
  v_permlane32_swap_b32 v4, v6
  v_max_f32 v4, v4, v6
  v_mov_b32 v6, v5
  s_nop 1
  v_permlane16_swap_b32 v5, v6
  v_max_f32 v5, v5, v6
  v_mov_b32 v6, v5
  s_nop 1
  v_permlane32_swap_b32 v5, v6
  v_max_f32 v5, v5, v6
  v_max_f32 v4, 0, v4
  v_add_f32 v2, v2, v4
  v_sub_f32 v128, v128, v4
  v_sub_f32 v129, v129, v4
  v_sub_f32 v130, v130, v4
  v_sub_f32 v131, v131, v4
  v_sub_f32 v136, v136, v4
  v_sub_f32 v137, v137, v4
  v_sub_f32 v138, v138, v4
  v_sub_f32 v139, v139, v4
  v_sub_f32 v144, v144, v4
  v_sub_f32 v145, v145, v4
  v_sub_f32 v146, v146, v4
  v_sub_f32 v147, v147, v4
  v_sub_f32 v152, v152, v4
  v_sub_f32 v153, v153, v4
  v_sub_f32 v154, v154, v4
  v_sub_f32 v155, v155, v4
  v_sub_f32 v196, 0, v2
  v_sub_f32 v197, 0, v2
  v_sub_f32 v198, 0, v2
  v_sub_f32 v199, 0, v2
  v_exp_f32 v4, -v4
  v_max_f32 v5, 0, v5
  v_add_f32 v3, v3, v5
  v_sub_f32 v132, v132, v5
  v_sub_f32 v133, v133, v5
  v_sub_f32 v134, v134, v5
  v_sub_f32 v135, v135, v5
  v_sub_f32 v140, v140, v5
  v_sub_f32 v141, v141, v5
  v_sub_f32 v142, v142, v5
  v_sub_f32 v143, v143, v5
  v_sub_f32 v148, v148, v5
  v_sub_f32 v149, v149, v5
  v_sub_f32 v150, v150, v5
  v_sub_f32 v151, v151, v5
  v_sub_f32 v156, v156, v5
  v_sub_f32 v157, v157, v5
  v_sub_f32 v158, v158, v5
  v_sub_f32 v159, v159, v5
  v_sub_f32 v200, 0, v3
  v_sub_f32 v201, 0, v3
  v_sub_f32 v202, 0, v3
  v_sub_f32 v203, 0, v3
  v_exp_f32 v5, -v5
  s_nop 0
  v_mul_f32 v184, v4, v184
  v_mul_f32 v64, v4, v64
  v_mul_f32 v65, v4, v65
  v_mul_f32 v66, v4, v66
  v_mul_f32 v67, v4, v67
  v_mul_f32 v68, v4, v68
  v_mul_f32 v69, v4, v69
  v_mul_f32 v70, v4, v70
  v_mul_f32 v71, v4, v71
  v_mul_f32 v72, v4, v72
  v_mul_f32 v73, v4, v73
  v_mul_f32 v74, v4, v74
  v_mul_f32 v75, v4, v75
  v_mul_f32 v76, v4, v76
  v_mul_f32 v77, v4, v77
  v_mul_f32 v78, v4, v78
  v_mul_f32 v79, v4, v79
  v_mul_f32 v96, v4, v96
  v_mul_f32 v97, v4, v97
  v_mul_f32 v98, v4, v98
  v_mul_f32 v99, v4, v99
  v_mul_f32 v100, v4, v100
  v_mul_f32 v101, v4, v101
  v_mul_f32 v102, v4, v102
  v_mul_f32 v103, v4, v103
  v_mul_f32 v104, v4, v104
  v_mul_f32 v105, v4, v105
  v_mul_f32 v106, v4, v106
  v_mul_f32 v107, v4, v107
  v_mul_f32 v108, v4, v108
  v_mul_f32 v109, v4, v109
  v_mul_f32 v110, v4, v110
  v_mul_f32 v111, v4, v111
  v_mul_f32 v188, v5, v188
  v_mul_f32 v80, v5, v80
  v_mul_f32 v81, v5, v81
  v_mul_f32 v82, v5, v82
  v_mul_f32 v83, v5, v83
  v_mul_f32 v84, v5, v84
  v_mul_f32 v85, v5, v85
  v_mul_f32 v86, v5, v86
  v_mul_f32 v87, v5, v87
  v_mul_f32 v88, v5, v88
  v_mul_f32 v89, v5, v89
  v_mul_f32 v90, v5, v90
  v_mul_f32 v91, v5, v91
  v_mul_f32 v92, v5, v92
  v_mul_f32 v93, v5, v93
  v_mul_f32 v94, v5, v94
  v_mul_f32 v95, v5, v95
  v_mul_f32 v112, v5, v112
  v_mul_f32 v113, v5, v113
  v_mul_f32 v114, v5, v114
  v_mul_f32 v115, v5, v115
  v_mul_f32 v116, v5, v116
  v_mul_f32 v117, v5, v117
  v_mul_f32 v118, v5, v118
  v_mul_f32 v119, v5, v119
  v_mul_f32 v120, v5, v120
  v_mul_f32 v121, v5, v121
  v_mul_f32 v122, v5, v122
  v_mul_f32 v123, v5, v123
  v_mul_f32 v124, v5, v124
  v_mul_f32 v125, v5, v125
  v_mul_f32 v126, v5, v126
  v_mul_f32 v127, v5, v127
  v_exp_f32 v24, v128
  v_exp_f32 v25, v129
  v_exp_f32 v26, v130
  v_exp_f32 v27, v131
  v_exp_f32 v28, v132
  v_exp_f32 v29, v133
  v_exp_f32 v30, v134
  v_cvt_pk_bf16_f32 v160, v24, v25
  v_exp_f32 v31, v135
  v_cvt_pk_bf16_f32 v161, v26, v27
  v_exp_f32 v24, v136
  v_cvt_pk_bf16_f32 v164, v28, v29
  v_exp_f32 v25, v137
  v_cvt_pk_bf16_f32 v165, v30, v31
  v_exp_f32 v26, v138
  v_cvt_pk_bf16_f32 v162, v24, v25
  v_exp_f32 v27, v139
  v_exp_f32 v28, v140
  v_cvt_pk_bf16_f32 v163, v26, v27
  v_exp_f32 v29, v141
  v_exp_f32 v30, v142
  v_cvt_pk_bf16_f32 v166, v28, v29
  v_exp_f32 v31, v143
  s_nop 0
  s_nop 0
  v_cvt_pk_bf16_f32 v167, v30, v31
  s_nop 1
  v_mfma_f32_16x16x32_bf16 v[176:179], v[192:195], v[160:163], v[184:187]
  v_mfma_f32_16x16x32_bf16 v[180:183], v[192:195], v[164:167], v[188:191]
  v_exp_f32 v24, v144
  v_exp_f32 v25, v145
  v_exp_f32 v26, v146
  v_exp_f32 v27, v147
  v_exp_f32 v28, v148
  v_exp_f32 v29, v149
  s_nop 7
  s_setpc_b64 s[66:67]
L_fixfn1:
  s_nop 7
  v_max3_f32 v4, v144, v145, v146
  v_max3_f32 v4, v4, v147, v152
  v_max3_f32 v4, v4, v153, v154
  v_max_f32 v4, v4, v155
  v_max3_f32 v5, v148, v149, v150
  v_max3_f32 v5, v5, v151, v156
  v_max3_f32 v5, v5, v157, v158
  v_max_f32 v5, v5, v159
  v_mov_b32 v6, v4
  s_nop 1
  v_permlane16_swap_b32 v4, v6
  v_max_f32 v4, v4, v6
  v_mov_b32 v6, v4
  s_nop 1
  v_permlane32_swap_b32 v4, v6
  v_max_f32 v4, v4, v6
  v_mov_b32 v6, v5
  s_nop 1
  v_permlane16_swap_b32 v5, v6
  v_max_f32 v5, v5, v6
  v_mov_b32 v6, v5
  s_nop 1
  v_permlane32_swap_b32 v5, v6
  v_max_f32 v5, v5, v6
  v_max_f32 v4, 0, v4
  v_add_f32 v2, v2, v4
  v_sub_f32 v128, v128, v4
  v_sub_f32 v129, v129, v4
  v_sub_f32 v130, v130, v4
  v_sub_f32 v131, v131, v4
  v_sub_f32 v136, v136, v4
  v_sub_f32 v137, v137, v4
  v_sub_f32 v138, v138, v4
  v_sub_f32 v139, v139, v4
  v_sub_f32 v144, v144, v4
  v_sub_f32 v145, v145, v4
  v_sub_f32 v146, v146, v4
  v_sub_f32 v147, v147, v4
  v_sub_f32 v152, v152, v4
  v_sub_f32 v153, v153, v4
  v_sub_f32 v154, v154, v4
  v_sub_f32 v155, v155, v4
  v_sub_f32 v196, 0, v2
  v_sub_f32 v197, 0, v2
  v_sub_f32 v198, 0, v2
  v_sub_f32 v199, 0, v2
  v_exp_f32 v4, -v4
  v_max_f32 v5, 0, v5
  v_add_f32 v3, v3, v5
  v_sub_f32 v132, v132, v5
  v_sub_f32 v133, v133, v5
  v_sub_f32 v134, v134, v5
  v_sub_f32 v135, v135, v5
  v_sub_f32 v140, v140, v5
  v_sub_f32 v141, v141, v5
  v_sub_f32 v142, v142, v5
  v_sub_f32 v143, v143, v5
  v_sub_f32 v148, v148, v5
  v_sub_f32 v149, v149, v5
  v_sub_f32 v150, v150, v5
  v_sub_f32 v151, v151, v5
  v_sub_f32 v156, v156, v5
  v_sub_f32 v157, v157, v5
  v_sub_f32 v158, v158, v5
  v_sub_f32 v159, v159, v5
  v_sub_f32 v200, 0, v3
  v_sub_f32 v201, 0, v3
  v_sub_f32 v202, 0, v3
  v_sub_f32 v203, 0, v3
  v_exp_f32 v5, -v5
  s_nop 0
  v_mul_f32 v176, v4, v176
  v_mul_f32 v64, v4, v64
  v_mul_f32 v65, v4, v65
  v_mul_f32 v66, v4, v66
  v_mul_f32 v67, v4, v67
  v_mul_f32 v68, v4, v68
  v_mul_f32 v69, v4, v69
  v_mul_f32 v70, v4, v70
  v_mul_f32 v71, v4, v71
  v_mul_f32 v72, v4, v72
  v_mul_f32 v73, v4, v73
  v_mul_f32 v74, v4, v74
  v_mul_f32 v75, v4, v75
  v_mul_f32 v76, v4, v76
  v_mul_f32 v77, v4, v77
  v_mul_f32 v78, v4, v78
  v_mul_f32 v79, v4, v79
  v_mul_f32 v96, v4, v96
  v_mul_f32 v97, v4, v97
  v_mul_f32 v98, v4, v98
  v_mul_f32 v99, v4, v99
  v_mul_f32 v100, v4, v100
  v_mul_f32 v101, v4, v101
  v_mul_f32 v102, v4, v102
  v_mul_f32 v103, v4, v103
  v_mul_f32 v104, v4, v104
  v_mul_f32 v105, v4, v105
  v_mul_f32 v106, v4, v106
  v_mul_f32 v107, v4, v107
  v_mul_f32 v108, v4, v108
  v_mul_f32 v109, v4, v109
  v_mul_f32 v110, v4, v110
  v_mul_f32 v111, v4, v111
  v_mul_f32 v180, v5, v180
  v_mul_f32 v80, v5, v80
  v_mul_f32 v81, v5, v81
  v_mul_f32 v82, v5, v82
  v_mul_f32 v83, v5, v83
  v_mul_f32 v84, v5, v84
  v_mul_f32 v85, v5, v85
  v_mul_f32 v86, v5, v86
  v_mul_f32 v87, v5, v87
  v_mul_f32 v88, v5, v88
  v_mul_f32 v89, v5, v89
  v_mul_f32 v90, v5, v90
  v_mul_f32 v91, v5, v91
  v_mul_f32 v92, v5, v92
  v_mul_f32 v93, v5, v93
  v_mul_f32 v94, v5, v94
  v_mul_f32 v95, v5, v95
  v_mul_f32 v112, v5, v112
  v_mul_f32 v113, v5, v113
  v_mul_f32 v114, v5, v114
  v_mul_f32 v115, v5, v115
  v_mul_f32 v116, v5, v116
  v_mul_f32 v117, v5, v117
  v_mul_f32 v118, v5, v118
  v_mul_f32 v119, v5, v119
  v_mul_f32 v120, v5, v120
  v_mul_f32 v121, v5, v121
  v_mul_f32 v122, v5, v122
  v_mul_f32 v123, v5, v123
  v_mul_f32 v124, v5, v124
  v_mul_f32 v125, v5, v125
  v_mul_f32 v126, v5, v126
  v_mul_f32 v127, v5, v127
  v_exp_f32 v24, v144
  v_exp_f32 v25, v145
  v_exp_f32 v26, v146
  v_exp_f32 v27, v147
  v_exp_f32 v28, v148
  v_exp_f32 v29, v149
  v_exp_f32 v30, v150
  v_cvt_pk_bf16_f32 v168, v24, v25
  v_exp_f32 v31, v151
  v_cvt_pk_bf16_f32 v169, v26, v27
  v_exp_f32 v24, v152
  v_cvt_pk_bf16_f32 v172, v28, v29
  v_exp_f32 v25, v153
  v_cvt_pk_bf16_f32 v173, v30, v31
  v_exp_f32 v26, v154
  v_cvt_pk_bf16_f32 v170, v24, v25
  v_exp_f32 v27, v155
  v_exp_f32 v28, v156
  v_cvt_pk_bf16_f32 v171, v26, v27
  v_exp_f32 v29, v157
  v_exp_f32 v30, v158
  v_cvt_pk_bf16_f32 v174, v28, v29
  v_exp_f32 v31, v159
  s_nop 0
  s_nop 0
  v_cvt_pk_bf16_f32 v175, v30, v31
  s_nop 1
  v_mfma_f32_16x16x32_bf16 v[184:187], v[192:195], v[168:171], v[176:179]
  v_mfma_f32_16x16x32_bf16 v[188:191], v[192:195], v[172:175], v[180:183]
  v_exp_f32 v24, v128
  v_exp_f32 v25, v129
  v_exp_f32 v26, v130
  v_exp_f32 v27, v131
  v_exp_f32 v28, v132
  v_exp_f32 v29, v133
  s_nop 7
  s_setpc_b64 s[66:67]
L_end:
  s_endpgm
.section .rodata,"a"
.p2align 6
.amdhsa_kernel standalone__gqa_softmax__sampling_kernel
  .amdhsa_next_free_vgpr 240
  .amdhsa_next_free_sgpr 102
  .amdhsa_accum_offset 240
  .amdhsa_group_segment_fixed_size 0
  .amdhsa_kernarg_size 48
  .amdhsa_user_sgpr_count 2
  .amdhsa_user_sgpr_kernarg_segment_ptr 1
  .amdhsa_system_sgpr_workgroup_id_x 1
.end_amdhsa_kernel
```
